```python
import torch

def _softmax(x, axis=-1):
    return torch.softmax(x, dim=axis)
def _gelu(x):
    return torch.nn.functional.gelu(x, approximate="tanh")
def _silu(x):
    return torch.nn.functional.silu(x)
def _sigmoid(x):
    return torch.sigmoid(x)
def _layernorm(x, axis=-1, eps=1e-5):
    m = x.mean(dim=axis, keepdim=True)
    v = x.var(dim=axis, keepdim=True, unbiased=False)
    return (x - m) / torch.sqrt(v + eps)
def _scatter_add(tgt, idx, src, axis=0):
    return tgt.clone().index_add_(axis, idx, src)
def _segment_sum(src, seg, n):
    out = torch.zeros((n,) + src.shape[1:], dtype=src.dtype)
    return out.index_add_(0, seg, src)
def _pad(x, pw):
    flat = tuple(v for pair in reversed(pw) for v in pair)
    return torch.nn.functional.pad(x, flat)

kernel_name = 'parallel_sum__linear_kernel_hedgehog__dense_activation_mish__prompt'

def setup_inputs():

    _w = (lambda a: (lambda t: t.to(torch.bfloat16) if t.is_floating_point() else t)(torch.as_tensor(a)))
    def _A_setup():
        B, S, D, H = 1, 2048, 512, 32
        Dh = D // H
        return {
            "x": _w((lambda *s: torch.randn(*s, dtype=torch.bfloat16) * 0.05)(B, S, D)),
            "wqkv": _w((lambda *s: torch.randn(*s, dtype=torch.bfloat16) * 0.2)(D, 3 * D)),
            "w_phi": _w((lambda *s: torch.randn(*s, dtype=torch.bfloat16) * 0.2)(H, Dh, Dh) * (Dh ** -0.5)),
            "wo": _w((lambda *s: torch.randn(*s, dtype=torch.bfloat16) * 0.05)(D, D)),
        }
    _A_in = _A_setup()

    def _B_setup():
        B, S, D, F = 1, 2048, 512, 1376
        return {
            "x": _w((lambda *s: torch.randn(*s, dtype=torch.bfloat16) * 0.05)(B, S, D)),
            "w1": _w((lambda *s: torch.randn(*s, dtype=torch.bfloat16) * 0.8)(D, F) * (D ** -0.5)),
            "b1": _w((lambda *s: torch.randn(*s, dtype=torch.bfloat16) * 0.2)(F)),
            "w2": _w((lambda *s: torch.randn(*s, dtype=torch.bfloat16) * 0.1)(F, D) * (F ** -0.5)),
        }
    _B_in = _B_setup()

    return {
        "A_x": _A_in["x"],
        "A_wqkv": _A_in["wqkv"],
        "A_w_phi": _A_in["w_phi"],
        "A_wo": _A_in["wo"],
        "B_x": _B_in["x"],
        "B_w1": _B_in["w1"],
        "B_b1": _B_in["b1"],
        "B_w2": _B_in["w2"],
    }

def reference(A_x, A_wqkv, A_w_phi, A_wo, B_x, B_w1, B_b1, B_w2):
    def _A_ref(x, wqkv, w_phi, wo):
        B, S, D = x.shape
        H = 32; Dh = D // H
        qkv = (lambda x, *d: x.permute(*d))((x @ wqkv).reshape(B, S, 3, H, Dh), 2, 0, 3, 1, 4)
        q, k, v = qkv[0], qkv[1], qkv[2]
        pq = torch.einsum("bhsd,hdf->bhsf", q, w_phi)
        pk = torch.einsum("bhsd,hdf->bhsf", k, w_phi)
        phi_q = torch.concatenate([_softmax(pq, axis=-1), _softmax(-pq, axis=-1)], axis=-1)
        phi_k = torch.concatenate([_softmax(pk, axis=-1), _softmax(-pk, axis=-1)], axis=-1)
        kv = torch.einsum("bhsf,bhsd->bhfd", phi_k, v)
        z  = torch.einsum("bhsf->bhf", phi_k)
        num = torch.einsum("bhqf,bhfd->bhqd", phi_q, kv)
        den = torch.einsum("bhqf,bhf->bhq", phi_q, z)[..., None] + 1e-6
        o = num / den
        return (lambda x, *d: x.permute(*d))(o, 0, 2, 1, 3).reshape(B, S, D) @ wo

    def _B_ref(x, w1, b1, w2):
        h = torch.einsum("bsd,df->bsf", x, w1) + b1
        sp = torch.log1p(torch.exp(-torch.abs(h))) + torch.where(h > 0, h, torch.zeros_like(h))
        act = h * torch.tanh(sp)
        return torch.einsum("bsf,fd->bsd", act, w2)

    x = A_x
    xn = _layernorm(x, axis=-1)
    return x + _A_ref(xn, A_wqkv, A_w_phi, A_wo) + _B_ref(xn, B_w1, B_b1, B_w2)
```

```asm
; @launch grid=(256,1,1) block=(512,1,1) lds=163840
.amdgcn_target "amdgcn-amd-amdhsa--gfx950"
.text
.globl parallel_sum__linear_kernel_hedgehog__dense_activation_mish__prompt_kernel
.p2align 8
.type parallel_sum__linear_kernel_hedgehog__dense_activation_mish__prompt_kernel,@function
parallel_sum__linear_kernel_hedgehog__dense_activation_mish__prompt_kernel:
    s_cmp_ge_u32 s2, 256
    s_cbranch_scc1 L_end
    s_getpc_b64 s[44:45]
L_pc:
    s_load_dwordx2 s[8:9], s[0:1], 0
    s_lshr_b32 s7, s2, 2
    s_and_b32 s7, s7, 32
    s_add_u32 s60, s7, 8
    s_load_dwordx2 s[12:13], s[0:1], s60
    s_bfe_u32 s6, s2, 0x30003
    v_lshrrev_b32 v24, 6, v0
    s_mov_b32 s46, L_end-L_pc
    v_lshl_add_u32 v25, v0, 3, s6
    s_mov_b32 s47, 0x00020000
    v_lshlrev_b32 v25, 7, v25
    v_readfirstlane_b32 s3, v24
    buffer_load_dword v251, v25, s[44:47], 0 offen
    s_setprio 3
    s_load_dwordx2 s[32:33], s[0:1], 80
    v_lshrrev_b32 v248, 3, v0
    s_sub_u32 s65, 40, s7
    s_and_b32 s7, s2, 1
    v_and_b32 v25, 56, v248
    s_lshl3_add_u32 s62, s7, s6
    v_add_u32 v24, v248, v25
    s_lshr_b32 s7, s2, 6
    v_bfe_u32 v26, v0, 4, 2
    s_lshl1_add_u32 s61, s7, s6
    v_bitop3_b32 v26, v0, v26, 7 bitop3:0x28
    s_lshl_b32 s59, s62, 17
    v_lshl_add_u32 v26, v26, 4, s59
    s_and_b32 s61, s61, 1
    v_lshl_add_u32 v1, v24, 10, v26
    s_lshl_b32 s61, s61, 7
    v_xor_b32 v2, 64, v1
    s_add_u32 s61, s61, 512
    s_lshl_b32 s56, s3, 11
    v_add_u32 v2, 7168, v2
    s_mov_b32 s10, 2097152
    v_bfe_u32 v27, v0, 4, 1
    s_mov_b32 s11, 0x00020000
    v_lshlrev_b32 v27, 2, v27
    s_mov_b32 m0, s56
    v_bitop3_b32 v27, v0, v27, 7 bitop3:0x28
    s_bfe_u32 s7, s2, 0x10006
    v_lshlrev_b32 v249, 4, v27
    s_and_b32 s63, s2, 6
    s_or_b32 s63, s63, s7
    s_mul_i32 s64, s63, 11
    s_waitcnt lgkmcnt(0)
    buffer_load_dwordx4 v1, s[8:11], s61 offen lds
    s_add_u32 s64, s64, 1
    s_lshr_b32 s64, s64, 1
    s_min_u32 s64, s64, 38
    s_lshl1_add_u32 s7, s63, 16
    buffer_load_dwordx4 v2, s[8:11], s61 offen offset:1024 lds
    s_movk_i32 s78, 1536
    s_movk_i32 s59, 1024
    s_bitcmp1_b32 s2, 7
    s_cselect_b32 s78, 1376, s78
    s_cselect_b32 s7, s64, s7
    s_cselect_b32 s59, 128, s59
    v_mul_u32_u24 v3, s78, v248
    s_lshl_b32 s7, s7, 6
    s_lshl_b32 s14, s78, 10
    v_lshl_add_u32 v3, v3, 1, v249
    s_mov_b32 s15, 0x00020000
    s_mov_b32 s6, s61
    v_add_u32 v3, s7, v3
    s_load_dwordx2 s[16:17], s[0:1], s65
    v_add_u32 v4, s59, v3
    s_add_u32 m0, s56, 65536
    s_mul_i32 s6, s6, s78
    buffer_load_dwordx4 v3, s[12:15], s6 offen lds
    s_add_u32 m0, s56, 66560
    s_nop 0
    buffer_load_dwordx4 v4, s[12:15], s6 offen lds
    v_and_b32 v0, 63, v0
    s_lshr_b32 s7, s2, 7
    s_lshl1_add_u32 s7, s62, s7
    v_lshlrev_b32 v7, 4, v0
    s_lshl3_add_u32 s7, s7, s63
    s_lshl3_add_u32 s77, s7, s3
    s_lshl_b32 s7, s77, 10
    s_mov_b32 s34, 268435456
    s_mov_b32 s35, 0x00020000
    s_lshr_b32 s5, s3, 2
    buffer_load_dwordx4 v[224:227], v7, s[8:11], s7 offen
    buffer_load_dword v250, off, s[32:35], 0 sc1
    s_setprio 0
    s_bitcmp1_b32 s2, 7
    s_cbranch_scc1 L_B
    s_load_dwordx2 s[36:37], s[0:1], 16
    s_load_dwordx2 s[40:41], s[0:1], 48
    s_load_dwordx2 s[20:21], s[0:1], 56
    s_load_dwordx2 s[24:25], s[0:1], 24
    s_load_dwordx2 s[28:29], s[0:1], 64
    s_and_b32 s4, s3, 3
    v_and_b32 v28, 31, v0
    s_xor_b32 s60, s4, s5
    v_lshrrev_b32 v29, 5, v0
    v_bfe_u32 v30, v0, 1, 3
    s_lshl_b32 s59, s4, 7
    v_xor_b32 v30, v29, v30
    s_add_u32 s59, s59, s60
    v_lshlrev_b32 v30, 4, v30
    s_lshl_b32 s59, s59, 5
    v_lshl_add_u32 v30, v28, 7, v30
    v_bfe_u32 v24, v0, 2, 2
    v_xor_b32 v40, s59, v30
    v_bfe_u32 v25, v0, 4, 1
    v_xor_b32 v41, 32, v40
    v_and_b32 v26, 3, v0
    v_xor_b32 v42, 64, v40
    v_lshlrev_b32 v26, 3, v26
    v_xor_b32 v43, 96, v40
    v_lshl_add_u32 v26, v25, 5, v26
    v_lshrrev_b32 v30, 1, v24
    s_lshl_b32 s59, s60, 6
    v_lshl_add_u32 v30, v30, 6, v26
    s_add_u32 s59, s59, s5
    v_lshl_add_u32 v27, v24, 7, v30
    s_lshl_b32 s59, s59, 6
    v_lshl_add_u32 v30, v29, 11, v27
    s_or_b32 s59, s59, 0x10000
    v_xor_b32 v31, v24, v25
    v_xor_b32 v20, s59, v30
    v_and_b32 v31, 1, v31
    v_xor_b32 v21, 4096, v20
    v_cmp_eq_u32 vcc, 0, v31
    v_xor_b32 v22, 8192, v20
    v_mov_b32 v31, 0x3f803f80
    v_xor_b32 v23, 12288, v20
    v_cndmask_b32 v44, 0, v31, vcc
    v_cndmask_b32 v45, 0, v31, vcc
    v_cndmask_b32 v46, 0, v31, vcc
    v_cndmask_b32 v47, 0, v31, vcc
    s_cmp_eq_u32 s5, 0
    s_cbranch_scc0 L_c0_1
    s_lshl2_add_u32 s59, s63, s4
    v_mov_b32 v244, -1
    s_lshl4_add_u32 s59, s59, s62
    s_mul_i32 s59, s59, 1152
    s_add_u32 s66, s59, 131072
    buffer_store_dwordx4 v[244:247], v7, s[32:35], s66 offen offset:0 sc1
    s_mov_b64 exec, 15
    buffer_store_dwordx4 v[244:247], v7, s[32:35], s66 offen offset:1024 sc1
    s_mov_b64 exec, -1
L_c0_1:
    s_add_u32 s64, s64, 4
    s_add_u32 s50, s64, s5
    s_and_b32 s59, s2, 7
    s_bfe_u32 s60, s2, 0x20003
    s_lshl2_add_u32 s74, s59, s60
    s_lshr_b32 s75, s2, 5
    s_xor_b32 s75, s75, 2
    s_mov_b32 s22, 1409024
    s_mov_b32 s23, 0x00020000
    s_mov_b32 s26, 524288
    s_mov_b32 s27, 0x00020000
    s_lshl3_add_u32 s59, s2, s3
    s_lshl_b32 s59, s59, 10
    s_mov_b32 s60, 0x40000000
    s_add_u32 s65, s59, 261120
    s_cmp_lt_u32 s2, 32
    s_cselect_b32 s60, s65, s60
    s_lshr_b32 s65, s2, 5
    s_cmp_eq_u32 s65, 1
    s_cselect_b32 s59, 0x40000000, s59
    s_add_u32 s65, s59, 15360
    s_and_b32 s7, s2, 0xc6
    s_cmp_eq_u32 s7, 0x40
    s_cselect_b32 s60, s65, s60
    s_cmp_eq_u32 s7, 0x42
    s_cselect_b32 s59, 0x40000000, s59
    v_lshl_add_u32 v252, v0, 7, s59
    v_lshl_add_u32 v253, v0, 7, s60
    v_cmp_gt_u32 vcc, 8, v0
    s_nop 1
    v_cndmask_b32 v252, v253, v252, vcc
    s_and_b32 s59, s2, 127
    s_lshl3_add_u32 s59, s59, s3
    s_mul_i32 s59, s59, 1536
    s_mov_b32 s60, 0x40000000
    s_add_u32 s65, s59, 391680
    s_cmp_lt_u32 s2, 32
    s_cselect_b32 s60, s65, s60
    s_lshr_b32 s65, s2, 5
    s_cmp_eq_u32 s65, 1
    s_cselect_b32 s59, 0x40000000, s59
    s_add_u32 s65, s59, 23040
    s_and_b32 s7, s2, 0xc6
    s_cmp_eq_u32 s7, 0x40
    s_cselect_b32 s60, s65, s60
    s_cmp_eq_u32 s7, 0x42
    s_cselect_b32 s59, 0x40000000, s59
    v_lshl_add_u32 v238, v0, 7, s59
    v_lshl_add_u32 v31, v0, 7, s60
    v_cmp_gt_u32 vcc, 12, v0
    s_nop 1
    v_cndmask_b32 v238, v31, v238, vcc
    s_bfe_u32 s60, s2, 0x20003
    v_add_u32 v253, 0xffea8000, v252
    s_lshl_b32 s60, s60, 1
    s_xor_b32 s60, s60, s75
    s_and_b32 s60, s60, 7
    s_lshl_b32 s70, s60, 11
    s_lshl_b32 s71, s60, 14
    s_lshr_b32 s60, s60, 1
    s_lshl_b32 s53, s60, 11
    s_lshl_b32 s54, s60, 14
    s_lshl1_add_u32 s76, s4, s5
    s_mul_i32 s65, s76, 11
    s_add_u32 s65, s65, 1
    s_lshr_b32 s65, s65, 1
    s_min_u32 s65, s65, 38
    v_and_b32 v31, 7, v248
    v_lshl_add_u32 v31, v31, 10, v249
    s_lshl_b32 s59, s65, 8
    s_add_u32 s59, s59, s75
    s_lshl_b32 s59, s59, 7
    v_add_u32 v32, s59, v31
    v_add_u32 v33, 7168, v32
    s_lshl_b32 s59, s76, 9
    s_add_u32 s59, s59, s75
    s_lshl_b32 s59, s59, 7
    v_add_u32 v34, s59, v31
    v_add_u32 v35, 7168, v34
    s_mul_i32 s59, s74, 59
    s_add_u32 s59, s59, s65
    s_lshl_b32 s59, s59, 12
    s_add_u32 s59, s59, 1310720
    v_add_u32 v37, s59, v7
    s_lshl1_add_u32 s60, s76, 43
    s_sub_u32 s60, s60, s65
    s_lshl_b32 s72, s60, 12
    s_mov_b32 s18, 1409024
    s_mov_b32 s19, 0x00020000
    s_lshl_b32 s59, s64, 6
    v_mul_u32_u24 v5, 2752, v248
    v_add3_u32 v5, v5, v249, s59
    v_lshlrev_b32 v8, 1, v28
    s_lshl4_add_u32 s77, s77, 4096
    s_lshl2_add_u32 s59, s62, s4
    s_lshl_b32 s59, s59, 9
    s_add_u32 s59, s59, 4096
    v_lshl_add_u32 v6, v28, 4, s59
    s_lshl_b32 s59, s5, 9
    s_add_u32 s59, s59, 151552
    v_lshl_add_u32 v15, v28, 4, s59
    s_lshl_b32 s59, s4, 2
    v_add_u32 v14, s59, v15
    v_lshl_add_u32 v27, v29, 9, v27
    v_add_u32 v38, s56, v27
    v_lshl_add_u32 v31, v29, 2, v24
    s_add_u32 m0, s56, 16384
    s_add_u32 s6, s61, 128
    s_and_b32 s6, s6, 0x380
    buffer_load_dwordx4 v1, s[8:11], s6 offen lds
    v_lshlrev_b32 v31, 5, v31
    v_lshl_add_u32 v31, v25, 4, v31
    v_bfe_u32 v27, v0, 1, 1
    v_lshl_add_u32 v31, v27, 3, v31
    s_lshl_b32 s59, s5, 10
    s_add_u32 s59, s59, 149504
    v_add_u32 v56, s59, v31
    v_bfe_i32 v57, v0, 2, 1
    v_and_b32 v57, 0x80008000, v57
    v_and_b32 v16, 0xffff, v20
    v_and_b32 v17, 0xffff, v21
    v_and_b32 v18, 0xffff, v22
    v_and_b32 v19, 0xffff, v23
    s_lshr_b32 s59, s74, 1
    s_lshl4_add_u32 s59, s59, s76
    s_lshl_b32 s59, s59, 7
    s_add_u32 s59, s59, 4096
    v_and_b32 v31, 8, v0
    v_mul_u32_u24 v31, 0x70, v31
    v_and_b32 v30, 15, v0
    v_lshl_add_u32 v31, v30, 4, v31
    v_add_u32 v36, s59, v31
    buffer_load_dwordx4 v2, s[8:11], s6 offen offset:1024 lds
    s_lshl_b32 s65, s4, 5
    v_add_u32 v28, s65, v28
    v_bfe_u32 v30, v0, 1, 2
    v_lshlrev_b32 v31, 1, v29
    v_xor_b32 v30, v30, v31
    s_lshl_b32 s59, s5, 14
    s_add_u32 s59, s59, 32768
    v_lshl_add_u32 v30, v30, 4, s59
    v_lshl_add_u32 v58, v28, 6, v30
    v_xor_b32 v59, 16, v58
    v_mul_u32_u24 v28, 144, v28
    v_add_u32 v28, 131072, v28
    v_mov_b32 v254, 0x3f803f80
    v_mov_b32 v255, 0x3f803f80
    ds_write_b64 v28, v[254:255] offset:128
    s_lshl_b32 s59, s5, 6
    v_lshl_add_u32 v63, v29, 4, s59
    v_add_u32 v63, v63, v28
    v_lshl_add_u32 v29, v29, 3, v24
    v_and_b32 v30, 1, v0
    v_lshl_add_u32 v30, v30, 1, v25
    s_add_u32 m0, s56, 81920
    s_mul_i32 s6, s6, s78
    buffer_load_dwordx4 v3, s[12:15], s6 offen lds
    v_lshrrev_b32 v31, 1, v24
    v_xor_b32 v30, v30, v31
    v_lshlrev_b32 v30, 4, v30
    v_lshl_add_u32 v30, v29, 6, v30
    v_lshl_add_u32 v30, v27, 3, v30
    s_lshl_b32 s59, s4, 13
    s_add_u32 s59, s59, 32768
    v_add_u32 v60, s59, v30
    v_xor_b32 v61, 32, v60
    v_mul_u32_u24 v29, 144, v29
    v_add_u32 v30, s65, v26
    v_cmp_eq_u32 vcc, 1, v25
    v_mov_b32 v31, 128
    v_add_u32 v29, 131072, v29
    v_cndmask_b32 v30, v30, v31, vcc
    v_add_u32 v62, v29, v30
    s_lshr_b32 s65, s4, 1
    s_lshl1_add_u32 s65, s62, s65
    s_mul_i32 s79, s65, 236
    s_and_b32 s65, s4, 1
    s_add_u32 s79, s79, s65
    s_lshl2_add_u32 s59, s50, s79
    s_add_u32 m0, s56, 82944
    s_nop 0
    buffer_load_dwordx4 v4, s[12:15], s6 offen lds
    s_lshl_b32 s59, s59, 10
    s_add_u32 s68, s59, 1310720
    s_mov_b32 s52, 753664
    s_lshl3_add_u32 s51, s77, s52
    s_lshr_b32 s59, 0xea, s63
    s_and_b32 s60, s59, s5
    s_lshl_b32 s60, s60, 28
    v_add_u32 v9, s60, v7
    s_and_b32 s59, s59, 1
    s_lshl_b32 s59, s59, 6
    v_and_b32 v31, s59, v249
    v_lshl_add_u32 v5, v31, 22, v5
    s_mov_b32 s30, 2097152
    s_mov_b32 s31, 0x00020000
    s_and_b32 s59, s74, 1
    s_lshl_b32 s59, s59, 1
    s_lshl3_add_u32 s59, s74, s3
    s_lshl_b32 s73, s59, 7
    s_add_u32 s73, s73, 4096
    s_lshl_b32 s59, s59, 6
    s_add_u32 s59, s59, s75
    s_lshl_b32 s69, s59, 7
    s_waitcnt lgkmcnt(0)
    s_waitcnt vmcnt(6)
    s_barrier
    ds_read_b128 v[128:131], v40 offset:0
    ds_read_b64_tr_b16 v[64:65], v20 offset:0
    ds_read_b64_tr_b16 v[66:67], v20 offset:512
    ds_read_b64_tr_b16 v[68:69], v20 offset:1024
    ds_read_b64_tr_b16 v[70:71], v20 offset:1536
    ds_read_b128 v[132:135], v41 offset:0
    ds_read_b64_tr_b16 v[72:73], v21 offset:0
    ds_read_b64_tr_b16 v[74:75], v21 offset:512
    ds_read_b64_tr_b16 v[76:77], v21 offset:1024
    ds_read_b64_tr_b16 v[78:79], v21 offset:1536
    s_waitcnt lgkmcnt(5)
    v_mfma_f32_32x32x16_bf16 v[96:111], v[64:67], v[128:131], 0
    ds_read_b128 v[136:139], v42 offset:0
    ds_read_b64_tr_b16 v[80:81], v22 offset:0
    ds_read_b64_tr_b16 v[82:83], v22 offset:512
    s_add_u32 m0, s56, 32768
    s_add_u32 s6, s61, 256
    s_and_b32 s6, s6, 0x380
    buffer_load_dwordx4 v1, s[8:11], s6 offen lds
    s_waitcnt vmcnt(5)
    v_add_u32 v243, 1, v250
    v_lshlrev_b32 v228, 16, v224
    v_and_b32 v229, 0xffff0000, v224
    v_lshlrev_b32 v230, 16, v225
    v_and_b32 v231, 0xffff0000, v225
    v_mfma_f32_32x32x16_bf16 v[112:127], v[68:71], v[128:131], 0
    ds_read_b64_tr_b16 v[84:85], v22 offset:1024
    ds_read_b64_tr_b16 v[86:87], v22 offset:1536
    buffer_load_dwordx4 v2, s[8:11], s6 offen offset:1024 lds
    v_mfma_f32_16x16x32_bf16 v[48:51], v[44:47], v[64:67], 0
    v_mfma_f32_16x16x32_bf16 v[52:55], v[44:47], v[68:71], 0
    v_lshlrev_b32 v232, 16, v226
    v_and_b32 v233, 0xffff0000, v226
    v_lshlrev_b32 v234, 16, v227
    v_and_b32 v235, 0xffff0000, v227
    s_waitcnt lgkmcnt(5)
    v_mfma_f32_32x32x16_bf16 v[96:111], v[72:75], v[132:135], v[96:111]
    ds_read_b128 v[140:143], v43 offset:0
    ds_read_b64_tr_b16 v[88:89], v23 offset:0
    ds_read_b64_tr_b16 v[90:91], v23 offset:512
    s_add_u32 m0, s56, 98304
    s_mul_i32 s6, s6, s78
    buffer_load_dwordx4 v3, s[12:15], s6 offen lds
    v_readfirstlane_b32 s57, v243
    v_add_f32 v224, v228, v229
    v_add_f32 v225, v230, v231
    v_add_f32 v226, v232, v233
    v_add_f32 v227, v234, v235
    v_mfma_f32_32x32x16_bf16 v[112:127], v[76:79], v[132:135], v[112:127]
    ds_read_b64_tr_b16 v[92:93], v23 offset:1024
    ds_read_b64_tr_b16 v[94:95], v23 offset:1536
    s_add_u32 m0, s56, 99328
    s_nop 0
    buffer_load_dwordx4 v4, s[12:15], s6 offen lds
    v_add_f32 v224, v224, v225
    v_add_f32 v226, v226, v227
    v_add_f32 v236, v224, v226
    s_nop 1
    v_add_f32_dpp v236, v236, v236 row_ror:8 row_mask:0xf bank_mask:0xf
    s_waitcnt vmcnt(4)
    s_barrier
    s_mov_b64 exec, 0xffffff
    buffer_load_dword v251, v238, s[12:15], 0 offen
    s_mov_b64 exec, -1
    s_waitcnt lgkmcnt(5)
    v_mfma_f32_32x32x16_bf16 v[96:111], v[80:83], v[136:139], v[96:111]
    ds_read_b128 v[144:147], v40 offset:16384
    ds_read_b64_tr_b16 v[64:65], v20 offset:16384
    ds_read_b64_tr_b16 v[66:67], v20 offset:16896
    v_add_f32_dpp v236, v236, v236 row_ror:4 row_mask:0xf bank_mask:0xf
    s_nop 1
    v_add_f32_dpp v236, v236, v236 row_ror:2 row_mask:0xf bank_mask:0xf
    s_nop 1
    v_add_f32_dpp v236, v236, v236 row_ror:1 row_mask:0xf bank_mask:0xf
    v_mov_b32 v237, v236
    s_nop 1
    v_permlane16_swap_b32 v236, v237
    v_mfma_f32_32x32x16_bf16 v[112:127], v[84:87], v[136:139], v[112:127]
    ds_read_b64_tr_b16 v[68:69], v20 offset:17408
    ds_read_b64_tr_b16 v[70:71], v20 offset:17920
    s_add_u32 m0, s56, 49152
    s_add_u32 s6, s61, 384
    s_and_b32 s6, s6, 0x380
    buffer_load_dwordx4 v1, s[8:11], s6 offen lds
    v_add_f32 v236, v236, v237
    v_mov_b32 v237, v236
    s_nop 1
    v_permlane32_swap_b32 v236, v237
    v_add_f32 v236, v236, v237
    s_waitcnt lgkmcnt(5)
    v_mfma_f32_32x32x16_bf16 v[96:111], v[88:91], v[140:143], v[96:111]
    ds_read_b128 v[148:151], v41 offset:16384
    ds_read_b64_tr_b16 v[72:73], v21 offset:16384
    ds_read_b64_tr_b16 v[74:75], v21 offset:16896
    v_mul_f32 v240, 0xbb000000, v236
    v_add_f32 v228, v228, v240
    v_add_f32 v229, v229, v240
    v_add_f32 v230, v230, v240
    v_add_f32 v231, v231, v240
    v_mfma_f32_32x32x16_bf16 v[112:127], v[92:95], v[140:143], v[112:127]
    ds_read_b64_tr_b16 v[76:77], v21 offset:17408
    ds_read_b64_tr_b16 v[78:79], v21 offset:17920
    buffer_load_dwordx4 v2, s[8:11], s6 offen offset:1024 lds
    v_add_f32 v232, v232, v240
    v_add_f32 v233, v233, v240
    v_add_f32 v234, v234, v240
    v_add_f32 v235, v235, v240
    s_waitcnt lgkmcnt(5)
    v_mfma_f32_32x32x16_bf16 v[96:111], v[64:67], v[144:147], v[96:111]
    ds_read_b128 v[152:155], v42 offset:16384
    ds_read_b64_tr_b16 v[80:81], v22 offset:16384
    ds_read_b64_tr_b16 v[82:83], v22 offset:16896
    v_mul_f32 v224, v228, v228
    v_mul_f32 v225, v229, v229
    v_mul_f32 v226, v230, v230
    v_mul_f32 v227, v231, v231
    v_fmac_f32 v224, v232, v232
    v_mfma_f32_32x32x16_bf16 v[112:127], v[68:71], v[144:147], v[112:127]
    ds_read_b64_tr_b16 v[84:85], v22 offset:17408
    ds_read_b64_tr_b16 v[86:87], v22 offset:17920
    s_add_u32 m0, s56, 114688
    s_mul_i32 s6, s6, s78
    buffer_load_dwordx4 v3, s[12:15], s6 offen lds
    v_mfma_f32_16x16x32_bf16 v[48:51], v[44:47], v[64:67], v[48:51]
    v_mfma_f32_16x16x32_bf16 v[52:55], v[44:47], v[68:71], v[52:55]
    v_fmac_f32 v225, v233, v233
    v_fmac_f32 v226, v234, v234
    v_fmac_f32 v227, v235, v235
    v_add_f32 v224, v224, v225
    s_waitcnt lgkmcnt(5)
    v_mfma_f32_32x32x16_bf16 v[96:111], v[72:75], v[148:151], v[96:111]
    ds_read_b128 v[156:159], v43 offset:16384
    ds_read_b64_tr_b16 v[88:89], v23 offset:16384
    ds_read_b64_tr_b16 v[90:91], v23 offset:16896
    v_add_f32 v226, v226, v227
    v_add_f32 v236, v224, v226
    s_nop 1
    v_add_f32_dpp v236, v236, v236 row_ror:8 row_mask:0xf bank_mask:0xf
    s_nop 1
    v_add_f32_dpp v236, v236, v236 row_ror:4 row_mask:0xf bank_mask:0xf
    s_nop 1
    v_add_f32_dpp v236, v236, v236 row_ror:2 row_mask:0xf bank_mask:0xf
    v_mfma_f32_32x32x16_bf16 v[112:127], v[76:79], v[148:151], v[112:127]
    ds_read_b64_tr_b16 v[92:93], v23 offset:17408
    ds_read_b64_tr_b16 v[94:95], v23 offset:17920
    s_add_u32 m0, s56, 115712
    s_nop 0
    buffer_load_dwordx4 v4, s[12:15], s6 offen lds
    v_add_f32_dpp v236, v236, v236 row_ror:1 row_mask:0xf bank_mask:0xf
    v_mov_b32 v237, v236
    s_nop 1
    v_permlane16_swap_b32 v236, v237
    v_add_f32 v236, v236, v237
    s_waitcnt vmcnt(5)
    s_barrier
    s_mov_b32 exec_lo, 0xffff
    s_mov_b32 exec_hi, 0x0
    buffer_load_dword v39, v252, s[20:23], 0 offen
    buffer_load_dword v39, v253, s[24:27], 0 offen
    s_mov_b64 exec, -1
    s_movk_i32 s42, 2752
    s_mov_b32 s43, 0x00020000
    s_lshl_b32 s65, s50, 6
    buffer_load_ushort v8, v8, s[40:43], s65 offen offset:0
    s_mov_b32 s38, 16384
    s_mov_b32 s39, 0x00020000
    s_and_b32 s59, s3, 1
    s_lshl_b32 s59, s59, 10
    s_lshl_b32 s60, s63, 11
    s_add_u32 s60, s60, s59
    s_add_u32 m0, s59, 149504
    s_mov_b32 s58, 200000
    buffer_load_dwordx4 v7, s[36:39], s60 offen lds
    buffer_load_dword v39, off, s[28:31], s69
    s_waitcnt lgkmcnt(5)
    v_mfma_f32_32x32x16_bf16 v[96:111], v[80:83], v[152:155], v[96:111]
    ds_read_b128 v[160:163], v40 offset:32768
    ds_read_b64_tr_b16 v[64:65], v20 offset:32768
    ds_read_b64_tr_b16 v[66:67], v20 offset:33280
    v_mov_b32 v237, v236
    s_nop 1
    v_permlane32_swap_b32 v236, v237
    v_add_f32 v236, v236, v237
    v_mov_b32 v237, 0x3727c5ac
    v_mfma_f32_32x32x16_bf16 v[112:127], v[84:87], v[152:155], v[112:127]
    ds_read_b64_tr_b16 v[68:69], v20 offset:33792
    ds_read_b64_tr_b16 v[70:71], v20 offset:34304
    s_add_u32 m0, s56, 0
    s_add_u32 s6, s61, 512
    s_and_b32 s6, s6, 0x380
    buffer_load_dwordx4 v1, s[8:11], s6 offen lds
    v_fmac_f32 v237, 0x3b000000, v236
    v_rsq_f32 v242, v237
    s_nop 0
    v_mul_f32 v241, v237, v242
    s_waitcnt lgkmcnt(5)
    v_mfma_f32_32x32x16_bf16 v[96:111], v[88:91], v[156:159], v[96:111]
    ds_read_b128 v[164:167], v41 offset:32768
    ds_read_b64_tr_b16 v[72:73], v21 offset:32768
    ds_read_b64_tr_b16 v[74:75], v21 offset:33280
    v_mfma_f32_32x32x16_bf16 v[112:127], v[92:95], v[156:159], v[112:127]
    ds_read_b64_tr_b16 v[76:77], v21 offset:33792
    ds_read_b64_tr_b16 v[78:79], v21 offset:34304
    buffer_load_dwordx4 v2, s[8:11], s6 offen offset:1024 lds
    s_mov_b64 exec, 1
    buffer_store_dwordx4 v[240:243], off, s[32:35], s77 sc1
    s_mov_b64 exec, -1
    s_waitcnt lgkmcnt(5)
    v_mfma_f32_32x32x16_bf16 v[96:111], v[64:67], v[160:163], v[96:111]
    ds_read_b128 v[168:171], v42 offset:32768
    ds_read_b64_tr_b16 v[80:81], v22 offset:32768
    ds_read_b64_tr_b16 v[82:83], v22 offset:33280
    v_mfma_f32_32x32x16_bf16 v[112:127], v[68:71], v[160:163], v[112:127]
    ds_read_b64_tr_b16 v[84:85], v22 offset:33792
    ds_read_b64_tr_b16 v[86:87], v22 offset:34304
    s_add_u32 m0, s56, 65536
    s_mul_i32 s6, s6, s78
    buffer_load_dwordx4 v3, s[12:15], s6 offen lds
    v_mfma_f32_16x16x32_bf16 v[48:51], v[44:47], v[64:67], v[48:51]
    v_mfma_f32_16x16x32_bf16 v[52:55], v[44:47], v[68:71], v[52:55]
    s_waitcnt lgkmcnt(5)
    v_mfma_f32_32x32x16_bf16 v[96:111], v[72:75], v[164:167], v[96:111]
    ds_read_b128 v[172:175], v43 offset:32768
    ds_read_b64_tr_b16 v[88:89], v23 offset:32768
    ds_read_b64_tr_b16 v[90:91], v23 offset:33280
    v_mfma_f32_32x32x16_bf16 v[112:127], v[76:79], v[164:167], v[112:127]
    ds_read_b64_tr_b16 v[92:93], v23 offset:33792
    ds_read_b64_tr_b16 v[94:95], v23 offset:34304
    s_add_u32 m0, s56, 66560
    s_nop 0
    buffer_load_dwordx4 v4, s[12:15], s6 offen lds
    s_waitcnt vmcnt(10)
    s_barrier
    s_waitcnt lgkmcnt(5)
    v_mfma_f32_32x32x16_bf16 v[96:111], v[80:83], v[168:171], v[96:111]
    ds_read_b128 v[176:179], v40 offset:49152
    ds_read_b64_tr_b16 v[64:65], v20 offset:49152
    ds_read_b64_tr_b16 v[66:67], v20 offset:49664
    v_mfma_f32_32x32x16_bf16 v[112:127], v[84:87], v[168:171], v[112:127]
    ds_read_b64_tr_b16 v[68:69], v20 offset:50176
    ds_read_b64_tr_b16 v[70:71], v20 offset:50688
    s_add_u32 m0, s56, 16384
    s_add_u32 s6, s61, 640
    s_and_b32 s6, s6, 0x380
    buffer_load_dwordx4 v1, s[8:11], s6 offen lds
    s_waitcnt lgkmcnt(5)
    v_mfma_f32_32x32x16_bf16 v[96:111], v[88:91], v[172:175], v[96:111]
    ds_read_b128 v[180:183], v41 offset:49152
    ds_read_b64_tr_b16 v[72:73], v21 offset:49152
    ds_read_b64_tr_b16 v[74:75], v21 offset:49664
    v_mfma_f32_32x32x16_bf16 v[112:127], v[92:95], v[172:175], v[112:127]
    ds_read_b64_tr_b16 v[76:77], v21 offset:50176
    ds_read_b64_tr_b16 v[78:79], v21 offset:50688
    buffer_load_dwordx4 v2, s[8:11], s6 offen offset:1024 lds
    s_waitcnt lgkmcnt(5)
    v_mfma_f32_32x32x16_bf16 v[96:111], v[64:67], v[176:179], v[96:111]
    ds_read_b128 v[184:187], v42 offset:49152
    ds_read_b64_tr_b16 v[80:81], v22 offset:49152
    ds_read_b64_tr_b16 v[82:83], v22 offset:49664
    v_mfma_f32_32x32x16_bf16 v[112:127], v[68:71], v[176:179], v[112:127]
    ds_read_b64_tr_b16 v[84:85], v22 offset:50176
    ds_read_b64_tr_b16 v[86:87], v22 offset:50688
    s_add_u32 m0, s56, 81920
    s_mul_i32 s6, s6, s78
    buffer_load_dwordx4 v3, s[12:15], s6 offen lds
    v_mfma_f32_16x16x32_bf16 v[48:51], v[44:47], v[64:67], v[48:51]
    v_mfma_f32_16x16x32_bf16 v[52:55], v[44:47], v[68:71], v[52:55]
    s_waitcnt lgkmcnt(5)
    v_mfma_f32_32x32x16_bf16 v[96:111], v[72:75], v[180:183], v[96:111]
    ds_read_b128 v[188:191], v43 offset:49152
    ds_read_b64_tr_b16 v[88:89], v23 offset:49152
    ds_read_b64_tr_b16 v[90:91], v23 offset:49664
    v_mfma_f32_32x32x16_bf16 v[112:127], v[76:79], v[180:183], v[112:127]
    ds_read_b64_tr_b16 v[92:93], v23 offset:50176
    ds_read_b64_tr_b16 v[94:95], v23 offset:50688
    s_add_u32 m0, s56, 82944
    s_nop 0
    buffer_load_dwordx4 v4, s[12:15], s6 offen lds
    s_waitcnt vmcnt(4)
    s_barrier
    s_waitcnt lgkmcnt(5)
    v_mfma_f32_32x32x16_bf16 v[96:111], v[80:83], v[184:187], v[96:111]
    ds_read_b128 v[192:195], v40 offset:0
    ds_read_b64_tr_b16 v[64:65], v20 offset:0
    ds_read_b64_tr_b16 v[66:67], v20 offset:512
    s_and_b32 s59, s74, 1
    v_mfma_f32_32x32x16_bf16 v[112:127], v[84:87], v[184:187], v[112:127]
    ds_read_b64_tr_b16 v[68:69], v20 offset:1024
    ds_read_b64_tr_b16 v[70:71], v20 offset:1536
    s_add_u32 m0, s56, 32768
    s_add_u32 s6, s61, 768
    s_and_b32 s6, s6, 0x380
    buffer_load_dwordx4 v1, s[8:11], s6 offen lds
    s_lshl_b32 s59, s59, 1
    s_waitcnt lgkmcnt(5)
    v_mfma_f32_32x32x16_bf16 v[96:111], v[88:91], v[188:191], v[96:111]
    ds_read_b128 v[196:199], v41 offset:0
    ds_read_b64_tr_b16 v[72:73], v21 offset:0
    ds_read_b64_tr_b16 v[74:75], v21 offset:512
    s_mov_b32 s36, -0.5
    v_mfma_f32_32x32x16_bf16 v[112:127], v[92:95], v[188:191], v[112:127]
    ds_read_b64_tr_b16 v[76:77], v21 offset:1024
    ds_read_b64_tr_b16 v[78:79], v21 offset:1536
    buffer_load_dwordx4 v2, s[8:11], s6 offen offset:1024 lds
    s_mov_b32 s37, -0.5
    s_waitcnt lgkmcnt(5)
    v_mfma_f32_32x32x16_bf16 v[96:111], v[64:67], v[192:195], v[96:111]
    ds_read_b128 v[200:203], v42 offset:0
    ds_read_b64_tr_b16 v[80:81], v22 offset:0
    ds_read_b64_tr_b16 v[82:83], v22 offset:512
    s_mov_b32 s38, 0x3f3504f3
    v_mfma_f32_32x32x16_bf16 v[112:127], v[68:71], v[192:195], v[112:127]
    ds_read_b64_tr_b16 v[84:85], v22 offset:1024
    ds_read_b64_tr_b16 v[86:87], v22 offset:1536
    s_add_u32 m0, s56, 98304
    s_mul_i32 s6, s6, s78
    buffer_load_dwordx4 v3, s[12:15], s6 offen lds
    v_mfma_f32_16x16x32_bf16 v[48:51], v[44:47], v[64:67], v[48:51]
    v_mfma_f32_16x16x32_bf16 v[52:55], v[44:47], v[68:71], v[52:55]
    s_mov_b32 s39, 0x3f3504f3
    s_waitcnt lgkmcnt(5)
    v_mfma_f32_32x32x16_bf16 v[96:111], v[72:75], v[196:199], v[96:111]
    ds_read_b128 v[204:207], v43 offset:0
    ds_read_b64_tr_b16 v[88:89], v23 offset:0
    ds_read_b64_tr_b16 v[90:91], v23 offset:512
    s_mov_b32 s40, -1
    v_mfma_f32_32x32x16_bf16 v[112:127], v[76:79], v[196:199], v[112:127]
    ds_read_b64_tr_b16 v[92:93], v23 offset:1024
    ds_read_b64_tr_b16 v[94:95], v23 offset:1536
    s_add_u32 m0, s56, 99328
    s_nop 0
    buffer_load_dwordx4 v4, s[12:15], s6 offen lds
    s_mov_b32 s41, 0
    s_waitcnt vmcnt(4)
    s_barrier
    s_waitcnt lgkmcnt(5)
    v_mfma_f32_32x32x16_bf16 v[96:111], v[80:83], v[200:203], v[96:111]
    ds_read_b128 v[208:211], v40 offset:16384
    ds_read_b64_tr_b16 v[64:65], v20 offset:16384
    ds_read_b64_tr_b16 v[66:67], v20 offset:16896
    s_mov_b32 s44, 0xffff0000
    v_mfma_f32_32x32x16_bf16 v[112:127], v[84:87], v[200:203], v[112:127]
    ds_read_b64_tr_b16 v[68:69], v20 offset:17408
    ds_read_b64_tr_b16 v[70:71], v20 offset:17920
    s_add_u32 m0, s56, 49152
    s_add_u32 s6, s61, 896
    s_and_b32 s6, s6, 0x380
    buffer_load_dwordx4 v1, s[8:11], s6 offen lds
    s_mov_b32 s45, 0
    s_waitcnt lgkmcnt(5)
    v_mfma_f32_32x32x16_bf16 v[96:111], v[88:91], v[204:207], v[96:111]
    ds_read_b128 v[212:215], v41 offset:16384
    ds_read_b64_tr_b16 v[72:73], v21 offset:16384
    ds_read_b64_tr_b16 v[74:75], v21 offset:16896
    s_lshl_b32 s42, 0x3333, s59
    v_mfma_f32_32x32x16_bf16 v[112:127], v[92:95], v[204:207], v[112:127]
    ds_read_b64_tr_b16 v[76:77], v21 offset:17408
    ds_read_b64_tr_b16 v[78:79], v21 offset:17920
    buffer_load_dwordx4 v2, s[8:11], s6 offen offset:1024 lds
    s_mov_b32 s43, 0
    s_waitcnt lgkmcnt(5)
    v_mfma_f32_32x32x16_bf16 v[96:111], v[64:67], v[208:211], v[96:111]
    ds_read_b128 v[216:219], v42 offset:16384
    ds_read_b64_tr_b16 v[80:81], v22 offset:16384
    ds_read_b64_tr_b16 v[82:83], v22 offset:16896
    v_mfma_f32_32x32x16_bf16 v[112:127], v[68:71], v[208:211], v[112:127]
    ds_read_b64_tr_b16 v[84:85], v22 offset:17408
    ds_read_b64_tr_b16 v[86:87], v22 offset:17920
    s_add_u32 m0, s56, 114688
    s_mul_i32 s6, s6, s78
    buffer_load_dwordx4 v3, s[12:15], s6 offen lds
    v_mfma_f32_16x16x32_bf16 v[48:51], v[44:47], v[64:67], v[48:51]
    v_mfma_f32_16x16x32_bf16 v[52:55], v[44:47], v[68:71], v[52:55]
    s_waitcnt lgkmcnt(5)
    v_mfma_f32_32x32x16_bf16 v[96:111], v[72:75], v[212:215], v[96:111]
    ds_read_b128 v[220:223], v43 offset:16384
    ds_read_b64_tr_b16 v[88:89], v23 offset:16384
    ds_read_b64_tr_b16 v[90:91], v23 offset:16896
    v_mfma_f32_32x32x16_bf16 v[112:127], v[76:79], v[212:215], v[112:127]
    ds_read_b64_tr_b16 v[92:93], v23 offset:17408
    ds_read_b64_tr_b16 v[94:95], v23 offset:17920
    s_add_u32 m0, s56, 115712
    s_nop 0
    buffer_load_dwordx4 v4, s[12:15], s6 offen lds
    s_waitcnt vmcnt(4)
    s_barrier
    s_waitcnt lgkmcnt(5)
    v_mfma_f32_32x32x16_bf16 v[96:111], v[80:83], v[216:219], v[96:111]
    ds_read_b128 v[224:227], v40 offset:32768
    ds_read_b64_tr_b16 v[64:65], v20 offset:32768
    ds_read_b64_tr_b16 v[66:67], v20 offset:33280
    v_mfma_f32_32x32x16_bf16 v[112:127], v[84:87], v[216:219], v[112:127]
    ds_read_b64_tr_b16 v[68:69], v20 offset:33792
    ds_read_b64_tr_b16 v[70:71], v20 offset:34304
    s_add_u32 m0, s56, 0
    s_add_u32 s6, s61, 0
    s_and_b32 s6, s6, 0x380
    s_mul_i32 s6, s6, 1376
    buffer_load_dwordx4 v5, s[16:19], s6 offen lds
    s_waitcnt lgkmcnt(5)
    v_mfma_f32_32x32x16_bf16 v[96:111], v[88:91], v[220:223], v[96:111]
    ds_read_b128 v[228:231], v41 offset:32768
    ds_read_b64_tr_b16 v[72:73], v21 offset:32768
    ds_read_b64_tr_b16 v[74:75], v21 offset:33280
    v_mfma_f32_32x32x16_bf16 v[112:127], v[92:95], v[220:223], v[112:127]
    ds_read_b64_tr_b16 v[76:77], v21 offset:33792
    ds_read_b64_tr_b16 v[78:79], v21 offset:34304
    s_add_u32 m0, s56, 1024
    s_add_u32 s6, s61, 128
    s_and_b32 s6, s6, 0x380
    s_mul_i32 s6, s6, 1376
    buffer_load_dwordx4 v5, s[16:19], s6 offen lds
    s_waitcnt lgkmcnt(5)
    v_mfma_f32_32x32x16_bf16 v[96:111], v[64:67], v[224:227], v[96:111]
    ds_read_b128 v[232:235], v42 offset:32768
    ds_read_b64_tr_b16 v[80:81], v22 offset:32768
    ds_read_b64_tr_b16 v[82:83], v22 offset:33280
    v_mfma_f32_32x32x16_bf16 v[112:127], v[68:71], v[224:227], v[112:127]
    ds_read_b64_tr_b16 v[84:85], v22 offset:33792
    ds_read_b64_tr_b16 v[86:87], v22 offset:34304
    s_add_u32 m0, s56, 65536
    s_add_u32 s6, s61, 256
    s_and_b32 s6, s6, 0x380
    s_mul_i32 s6, s6, 1376
    buffer_load_dwordx4 v5, s[16:19], s6 offen lds
    v_mfma_f32_16x16x32_bf16 v[48:51], v[44:47], v[64:67], v[48:51]
    v_mfma_f32_16x16x32_bf16 v[52:55], v[44:47], v[68:71], v[52:55]
    buffer_load_dwordx4 v[10:13], v6, s[32:35], 0 offen sc1
    s_waitcnt lgkmcnt(5)
    v_mfma_f32_32x32x16_bf16 v[96:111], v[72:75], v[228:231], v[96:111]
    ds_read_b128 v[236:239], v43 offset:32768
    ds_read_b64_tr_b16 v[88:89], v23 offset:32768
    ds_read_b64_tr_b16 v[90:91], v23 offset:33280
    v_mfma_f32_32x32x16_bf16 v[112:127], v[76:79], v[228:231], v[112:127]
    ds_read_b64_tr_b16 v[92:93], v23 offset:33792
    ds_read_b64_tr_b16 v[94:95], v23 offset:34304
    s_add_u32 m0, s56, 66560
    s_add_u32 s6, s61, 384
    s_and_b32 s6, s6, 0x380
    s_mul_i32 s6, s6, 1376
    buffer_load_dwordx4 v5, s[16:19], s6 offen lds
    s_waitcnt vmcnt(5)
    s_barrier
    s_waitcnt lgkmcnt(5)
    v_mfma_f32_32x32x16_bf16 v[96:111], v[80:83], v[232:235], v[96:111]
    ds_read_b128 v[240:243], v40 offset:49152
    ds_read_b64_tr_b16 v[64:65], v20 offset:49152
    ds_read_b64_tr_b16 v[66:67], v20 offset:49664
    v_mfma_f32_32x32x16_bf16 v[112:127], v[84:87], v[232:235], v[112:127]
    ds_read_b64_tr_b16 v[68:69], v20 offset:50176
    ds_read_b64_tr_b16 v[70:71], v20 offset:50688
    s_add_u32 m0, s56, 16384
    s_add_u32 s6, s61, 512
    s_and_b32 s6, s6, 0x380
    s_mul_i32 s6, s6, 1376
    buffer_load_dwordx4 v5, s[16:19], s6 offen lds
    s_waitcnt lgkmcnt(5)
    v_mfma_f32_32x32x16_bf16 v[96:111], v[88:91], v[236:239], v[96:111]
    ds_read_b128 v[244:247], v41 offset:49152
    ds_read_b64_tr_b16 v[72:73], v21 offset:49152
    ds_read_b64_tr_b16 v[74:75], v21 offset:49664
    v_mov_b32 v24, -1
    v_mfma_f32_32x32x16_bf16 v[112:127], v[92:95], v[236:239], v[112:127]
    ds_read_b64_tr_b16 v[76:77], v21 offset:50176
    ds_read_b64_tr_b16 v[78:79], v21 offset:50688
    s_add_u32 m0, s56, 17408
    s_add_u32 s6, s61, 640
    s_and_b32 s6, s6, 0x380
    s_mul_i32 s6, s6, 1376
    buffer_load_dwordx4 v5, s[16:19], s6 offen lds
    s_waitcnt lgkmcnt(5)
    v_mfma_f32_32x32x16_bf16 v[96:111], v[64:67], v[240:243], v[96:111]
    ds_read_b128 v[248:251], v42 offset:49152
    ds_read_b64_tr_b16 v[80:81], v22 offset:49152
    ds_read_b64_tr_b16 v[82:83], v22 offset:49664
    buffer_store_dwordx4 v[24:27], v9, s[32:35], s68 offen offset:0 sc1
    v_mfma_f32_32x32x16_bf16 v[112:127], v[68:71], v[240:243], v[112:127]
    ds_read_b64_tr_b16 v[84:85], v22 offset:50176
    ds_read_b64_tr_b16 v[86:87], v22 offset:50688
    s_add_u32 m0, s56, 81920
    s_add_u32 s6, s61, 768
    s_and_b32 s6, s6, 0x380
    s_mul_i32 s6, s6, 1376
    buffer_load_dwordx4 v5, s[16:19], s6 offen lds
    v_mfma_f32_16x16x32_bf16 v[48:51], v[44:47], v[64:67], v[48:51]
    v_mfma_f32_16x16x32_bf16 v[52:55], v[44:47], v[68:71], v[52:55]
    buffer_store_dwordx4 v[24:27], v9, s[32:35], s68 offen offset:2048 sc1
    s_waitcnt lgkmcnt(5)
    v_mfma_f32_32x32x16_bf16 v[96:111], v[72:75], v[244:247], v[96:111]
    ds_read_b128 v[252:255], v43 offset:49152
    ds_read_b64_tr_b16 v[88:89], v23 offset:49152
    ds_read_b64_tr_b16 v[90:91], v23 offset:49664
    s_nop 0
    ds_write_b32 v14, v48 offset:0
    ds_write_b32 v14, v52 offset:1024
    v_mfma_f32_32x32x16_bf16 v[112:127], v[76:79], v[244:247], v[112:127]
    ds_read_b64_tr_b16 v[92:93], v23 offset:50176
    ds_read_b64_tr_b16 v[94:95], v23 offset:50688
    s_add_u32 m0, s56, 82944
    s_add_u32 s6, s61, 896
    s_and_b32 s6, s6, 0x380
    s_mul_i32 s6, s6, 1376
    buffer_load_dwordx4 v5, s[16:19], s6 offen lds
    s_waitcnt vmcnt(7)
L_rec1_2_c:
    v_cmp_ne_u32 vcc, s57, v13
    s_cbranch_vccnz L_rec1_2_r
L_rec1_2_k:
    s_nop 0
    v_cndmask_b32 v10, v11, v10, s[40:41]
    v_mov_b32 v13, v12
    v_mul_f32 v12, 0x3fb8aa3b, v12
    s_waitcnt vmcnt(6)
    s_waitcnt lgkmcnt(0)
    s_barrier
    v_mfma_f32_32x32x16_bf16 v[96:111], v[80:83], v[248:251], v[96:111]
    ds_read_b64_tr_b16 v[64:65], v16 offset:0
    ds_read_b64_tr_b16 v[66:67], v16 offset:512
    ds_read_b64_tr_b16 v[68:69], v17 offset:0
    ds_read_b128 v[24:27], v15 offset:0
    ds_read_b128 v[28:31], v15 offset:1024
    v_mov_b32 v1, v38
    v_xor_b32 v2, 64, v38
    v_add_u32 v3, 65536, v1
    v_add_u32 v4, 65536, v2
    v_add_u32 v5, 131072, v1
    v_add_u32 v6, 131072, v2
    v_mfma_f32_32x32x16_bf16 v[112:127], v[84:87], v[248:251], v[112:127]
    ds_read_b64_tr_b16 v[70:71], v17 offset:512
    v_mov_b32 v38, -1
    ds_read_b64_tr_b16 v[40:41], v56 offset:0
    ds_read_b64_tr_b16 v[42:43], v56 offset:256
    ds_read_b64_tr_b16 v[52:53], v56 offset:512
    ds_read_b64_tr_b16 v[54:55], v56 offset:768
    v_mfma_f32_32x32x16_bf16 v[96:111], v[88:91], v[252:255], v[96:111]
    ds_read_b64_tr_b16 v[72:73], v18 offset:0
    ds_read_b64_tr_b16 v[74:75], v18 offset:512
    s_add_u32 m0, s56, 98304
    s_xor_b32 s6, s71, 114688
    buffer_load_dwordx4 v32, s[20:23], s6 offen lds
    buffer_load_dwordx4 v33, s[20:23], s6 offen offset:1024 lds
    v_mfma_f32_32x32x16_bf16 v[112:127], v[92:95], v[252:255], v[112:127]
    s_waitcnt lgkmcnt(7)
    v_add_f32 v24, v24, v25
    v_add_f32 v26, v26, v27
    v_add_f32 v28, v28, v29
    v_add_f32 v30, v30, v31
    v_add_f32 v24, v24, v26
    v_add_f32 v28, v28, v30
    v_cndmask_b32 v24, 0, v24, s[40:41]
    v_cndmask_b32 v28, 0, v28, s[40:41]
    v_mfma_f32_16x16x32_bf16 v[48:51], v[44:47], v[64:67], 0
    v_mfma_f32_32x32x16_bf16 v[80:95], v[64:67], v[128:131], 0
    ds_read_b64_tr_b16 v[76:77], v19 offset:0
    ds_read_b64_tr_b16 v[78:79], v19 offset:512
    v_mfma_f32_32x32x2_f32 v[96:111], v24, v10, v[96:111]
    v_mfma_f32_32x32x2_f32 v[112:127], v28, v10, v[112:127]
    s_waitcnt lgkmcnt(4)
    v_xor_b32 v40, v57, v40
    v_xor_b32 v41, v57, v41
    v_xor_b32 v42, v57, v42
    v_xor_b32 v43, v57, v43
    v_xor_b32 v52, v57, v52
    v_xor_b32 v53, v57, v53
    v_xor_b32 v54, v57, v54
    v_xor_b32 v55, v57, v55
    v_mfma_f32_32x32x16_bf16 v[80:95], v[68:71], v[132:135], v[80:95]
    ds_read_b64_tr_b16 v[64:65], v16 offset:1024
    ds_read_b64_tr_b16 v[66:67], v16 offset:1536
    s_nop 4
    v_cvt_pk_bf16_f32 v24, v96, v97
    v_cvt_pk_bf16_f32 v25, v98, v99
    v_cvt_pk_bf16_f32 v26, v100, v101
    v_cvt_pk_bf16_f32 v27, v102, v103
    v_cvt_pk_bf16_f32 v28, v104, v105
    v_cvt_pk_bf16_f32 v29, v106, v107
    v_cvt_pk_bf16_f32 v30, v108, v109
    v_cvt_pk_bf16_f32 v31, v110, v111
    v_mul_f32 v112, v112, v13
    v_mul_f32 v113, v113, v13
    v_mfma_f32_32x32x16_bf16 v[96:111], v[40:43], v[24:27], 0
    v_mul_f32 v114, v114, v13
    v_mul_f32 v115, v115, v13
    v_mul_f32 v116, v116, v13
    v_mul_f32 v117, v117, v13
    v_mul_f32 v118, v118, v13
    v_mul_f32 v119, v119, v13
    v_cvt_pk_bf16_f32 v112, v112, v113
    v_cvt_pk_bf16_f32 v113, v114, v115
    v_cvt_pk_bf16_f32 v114, v116, v117
    v_cvt_pk_bf16_f32 v115, v118, v119
    ds_write_b128 v63, v[112:115] offset:0
    v_mul_f32 v120, v120, v13
    v_mul_f32 v121, v121, v13
    v_mul_f32 v122, v122, v13
    v_mul_f32 v123, v123, v13
    v_mul_f32 v124, v124, v13
    v_mul_f32 v125, v125, v13
    v_mul_f32 v126, v126, v13
    v_mul_f32 v127, v127, v13
    v_cvt_pk_bf16_f32 v120, v120, v121
    v_cvt_pk_bf16_f32 v121, v122, v123
    v_cvt_pk_bf16_f32 v122, v124, v125
    v_cvt_pk_bf16_f32 v123, v126, v127
    ds_write_b128 v63, v[120:123] offset:32
    v_mfma_f32_32x32x16_bf16 v[112:127], v[52:55], v[28:31], 0
    v_max3_f32 v24, v96, v97, v98
    v_max3_f32 v25, v99, v100, v101
    v_max3_f32 v24, v24, v102, v103
    v_max3_f32 v25, v25, v104, v105
    v_max3_f32 v24, v24, v106, v107
    v_max3_f32 v25, v25, v108, v109
    v_max3_f32 v24, v24, v110, v111
    v_max_f32 v24, v24, v25
    v_mul_f32 v24, v24, v12
    v_pk_fma_f32 v[96:97], v[96:97], v[12:13], v[24:25] op_sel_hi:[1,0,0] neg_lo:[0,0,1] neg_hi:[0,0,1]
    v_pk_fma_f32 v[98:99], v[98:99], v[12:13], v[24:25] op_sel_hi:[1,0,0] neg_lo:[0,0,1] neg_hi:[0,0,1]
    v_pk_fma_f32 v[100:101], v[100:101], v[12:13], v[24:25] op_sel_hi:[1,0,0] neg_lo:[0,0,1] neg_hi:[0,0,1]
    s_waitcnt lgkmcnt(6)
    v_mfma_f32_32x32x16_bf16 v[80:95], v[72:75], v[136:139], v[80:95]
    ds_read_b64_tr_b16 v[68:69], v17 offset:1024
    ds_read_b64_tr_b16 v[70:71], v17 offset:1536
    v_pk_fma_f32 v[102:103], v[102:103], v[12:13], v[24:25] op_sel_hi:[1,0,0] neg_lo:[0,0,1] neg_hi:[0,0,1]
    v_pk_fma_f32 v[104:105], v[104:105], v[12:13], v[24:25] op_sel_hi:[1,0,0] neg_lo:[0,0,1] neg_hi:[0,0,1]
    v_pk_fma_f32 v[106:107], v[106:107], v[12:13], v[24:25] op_sel_hi:[1,0,0] neg_lo:[0,0,1] neg_hi:[0,0,1]
    v_pk_fma_f32 v[108:109], v[108:109], v[12:13], v[24:25] op_sel_hi:[1,0,0] neg_lo:[0,0,1] neg_hi:[0,0,1]
    v_pk_fma_f32 v[110:111], v[110:111], v[12:13], v[24:25] op_sel_hi:[1,0,0] neg_lo:[0,0,1] neg_hi:[0,0,1]
    v_exp_f32 v96, v96
    v_exp_f32 v97, v97
    v_exp_f32 v98, v98
    v_exp_f32 v99, v99
    v_exp_f32 v100, v100
    s_add_u32 m0, s56, 114688
    s_mov_b32 s6, 131072
    buffer_load_dwordx4 v32, s[20:23], s6 offen lds
    buffer_load_dwordx4 v33, s[20:23], s6 offen offset:1024 lds
    v_exp_f32 v101, v101
    v_exp_f32 v102, v102
    v_exp_f32 v103, v103
    v_exp_f32 v104, v104
    v_exp_f32 v105, v105
    v_exp_f32 v106, v106
    v_exp_f32 v107, v107
    v_exp_f32 v108, v108
    v_exp_f32 v109, v109
    v_exp_f32 v110, v110
    v_exp_f32 v111, v111
    v_pk_add_f32 v[24:25], v[96:97], v[98:99]
    v_pk_add_f32 v[26:27], v[100:101], v[102:103]
    v_pk_add_f32 v[24:25], v[24:25], v[104:105]
    v_pk_add_f32 v[26:27], v[26:27], v[106:107]
    v_pk_add_f32 v[24:25], v[24:25], v[108:109]
    v_pk_add_f32 v[26:27], v[26:27], v[110:111]
    s_waitcnt lgkmcnt(6)
    v_mfma_f32_32x32x16_bf16 v[80:95], v[76:79], v[140:143], v[80:95]
    ds_read_b64_tr_b16 v[72:73], v18 offset:1024
    ds_read_b64_tr_b16 v[74:75], v18 offset:1536
    v_pk_add_f32 v[24:25], v[24:25], v[26:27]
    v_add_f32 v24, v24, v25
    v_rcp_f32 v24, v24
    s_nop 0
    v_pk_mul_f32 v[96:97], v[96:97], v[24:25] op_sel_hi:[1,0]
    v_pk_mul_f32 v[98:99], v[98:99], v[24:25] op_sel_hi:[1,0]
    v_pk_mul_f32 v[100:101], v[100:101], v[24:25] op_sel_hi:[1,0]
    v_pk_mul_f32 v[102:103], v[102:103], v[24:25] op_sel_hi:[1,0]
    v_pk_mul_f32 v[104:105], v[104:105], v[24:25] op_sel_hi:[1,0]
    v_pk_mul_f32 v[106:107], v[106:107], v[24:25] op_sel_hi:[1,0]
    v_pk_mul_f32 v[108:109], v[108:109], v[24:25] op_sel_hi:[1,0]
    v_pk_mul_f32 v[110:111], v[110:111], v[24:25] op_sel_hi:[1,0]
    v_cvt_pk_bf16_f32 v96, v96, v97
    v_cvt_pk_bf16_f32 v97, v98, v99
    v_cvt_pk_bf16_f32 v98, v100, v101
    v_cvt_pk_bf16_f32 v99, v102, v103
    v_cvt_pk_bf16_f32 v100, v104, v105
    v_cvt_pk_bf16_f32 v101, v106, v107
    v_cvt_pk_bf16_f32 v102, v108, v109
    v_cvt_pk_bf16_f32 v103, v110, v111
    ds_write_b128 v58, v[96:99] offset:0
    ds_write_b128 v59, v[100:103] offset:0
    v_max3_f32 v24, v112, v113, v114
    v_max3_f32 v25, v115, v116, v117
    v_max3_f32 v24, v24, v118, v119
    v_max3_f32 v25, v25, v120, v121
    v_max3_f32 v24, v24, v122, v123
    v_max3_f32 v25, v25, v124, v125
    v_max3_f32 v24, v24, v126, v127
    v_max_f32 v24, v24, v25
    v_mul_f32 v24, v24, v12
    v_pk_fma_f32 v[112:113], v[112:113], v[12:13], v[24:25] op_sel_hi:[1,0,0] neg_lo:[0,0,1] neg_hi:[0,0,1]
    v_pk_fma_f32 v[114:115], v[114:115], v[12:13], v[24:25] op_sel_hi:[1,0,0] neg_lo:[0,0,1] neg_hi:[0,0,1]
    v_pk_fma_f32 v[116:117], v[116:117], v[12:13], v[24:25] op_sel_hi:[1,0,0] neg_lo:[0,0,1] neg_hi:[0,0,1]
    v_pk_fma_f32 v[118:119], v[118:119], v[12:13], v[24:25] op_sel_hi:[1,0,0] neg_lo:[0,0,1] neg_hi:[0,0,1]
    v_pk_fma_f32 v[120:121], v[120:121], v[12:13], v[24:25] op_sel_hi:[1,0,0] neg_lo:[0,0,1] neg_hi:[0,0,1]
    v_pk_fma_f32 v[122:123], v[122:123], v[12:13], v[24:25] op_sel_hi:[1,0,0] neg_lo:[0,0,1] neg_hi:[0,0,1]
    v_pk_fma_f32 v[124:125], v[124:125], v[12:13], v[24:25] op_sel_hi:[1,0,0] neg_lo:[0,0,1] neg_hi:[0,0,1]
    v_pk_fma_f32 v[126:127], v[126:127], v[12:13], v[24:25] op_sel_hi:[1,0,0] neg_lo:[0,0,1] neg_hi:[0,0,1]
    v_exp_f32 v112, v112
    v_exp_f32 v113, v113
    v_exp_f32 v114, v114
    v_exp_f32 v115, v115
    v_exp_f32 v116, v116
    v_exp_f32 v117, v117
    s_waitcnt lgkmcnt(8)
    v_mfma_f32_16x16x32_bf16 v[48:51], v[44:47], v[64:67], v[48:51]
    v_mfma_f32_32x32x16_bf16 v[80:95], v[64:67], v[144:147], v[80:95]
    ds_read_b64_tr_b16 v[76:77], v19 offset:1024
    ds_read_b64_tr_b16 v[78:79], v19 offset:1536
    v_exp_f32 v118, v118
    v_exp_f32 v119, v119
    v_exp_f32 v120, v120
    v_exp_f32 v121, v121
    v_exp_f32 v122, v122
    v_exp_f32 v123, v123
    v_exp_f32 v124, v124
    v_exp_f32 v125, v125
    v_exp_f32 v126, v126
    v_exp_f32 v127, v127
    v_pk_add_f32 v[24:25], v[112:113], v[114:115]
    v_pk_add_f32 v[26:27], v[116:117], v[118:119]
    v_pk_add_f32 v[24:25], v[24:25], v[120:121]
    v_pk_add_f32 v[26:27], v[26:27], v[122:123]
    v_pk_add_f32 v[24:25], v[24:25], v[124:125]
    v_pk_add_f32 v[26:27], v[26:27], v[126:127]
    v_pk_add_f32 v[24:25], v[24:25], v[26:27]
    v_add_f32 v24, v24, v25
    v_rcp_f32 v24, v24
    s_nop 0
    v_pk_mul_f32 v[112:113], v[112:113], v[24:25] op_sel_hi:[1,0]
    v_pk_mul_f32 v[114:115], v[114:115], v[24:25] op_sel_hi:[1,0]
    v_pk_mul_f32 v[116:117], v[116:117], v[24:25] op_sel_hi:[1,0]
    v_pk_mul_f32 v[118:119], v[118:119], v[24:25] op_sel_hi:[1,0]
    v_pk_mul_f32 v[120:121], v[120:121], v[24:25] op_sel_hi:[1,0]
    v_pk_mul_f32 v[122:123], v[122:123], v[24:25] op_sel_hi:[1,0]
    v_pk_mul_f32 v[124:125], v[124:125], v[24:25] op_sel_hi:[1,0]
    v_pk_mul_f32 v[126:127], v[126:127], v[24:25] op_sel_hi:[1,0]
    v_cvt_pk_bf16_f32 v112, v112, v113
    v_cvt_pk_bf16_f32 v113, v114, v115
    v_cvt_pk_bf16_f32 v114, v116, v117
    v_cvt_pk_bf16_f32 v115, v118, v119
    v_cvt_pk_bf16_f32 v116, v120, v121
    v_cvt_pk_bf16_f32 v117, v122, v123
    v_cvt_pk_bf16_f32 v118, v124, v125
    v_cvt_pk_bf16_f32 v119, v126, v127
    ds_write_b128 v58, v[112:115] offset:8192
    ds_write_b128 v59, v[116:119] offset:8192
    s_waitcnt lgkmcnt(0)
    s_barrier
    s_cmp_eq_u32 s5, 0
    s_cbranch_scc0 L_kv_3
    s_setprio 2
    ds_read_b64_tr_b16 v[112:113], v60 offset:0
    ds_read_b64_tr_b16 v[114:115], v61 offset:256
    ds_read_b64_tr_b16 v[116:117], v62 offset:0
    ds_read_b64_tr_b16 v[118:119], v62 offset:576
    ds_read_b64_tr_b16 v[120:121], v60 offset:1024
    ds_read_b64_tr_b16 v[122:123], v61 offset:1280
    ds_read_b64_tr_b16 v[124:125], v62 offset:2304
    ds_read_b64_tr_b16 v[126:127], v62 offset:2880
    ds_read_b64_tr_b16 v[24:25], v60 offset:2048
    ds_read_b64_tr_b16 v[26:27], v61 offset:2304
    ds_read_b64_tr_b16 v[28:29], v62 offset:4608
    ds_read_b64_tr_b16 v[30:31], v62 offset:5184
    s_waitcnt lgkmcnt(8)
    v_mfma_f32_32x32x16_bf16 v[96:111], v[112:115], v[116:119], 0
    s_waitcnt lgkmcnt(4)
    v_mfma_f32_32x32x16_bf16 v[96:111], v[120:123], v[124:127], v[96:111]
    ds_read_b64_tr_b16 v[112:113], v60 offset:3072
    ds_read_b64_tr_b16 v[114:115], v61 offset:3328
    ds_read_b64_tr_b16 v[116:117], v62 offset:6912
    ds_read_b64_tr_b16 v[118:119], v62 offset:7488
    s_waitcnt lgkmcnt(4)
    v_mfma_f32_32x32x16_bf16 v[96:111], v[24:27], v[28:31], v[96:111]
    ds_read_b64_tr_b16 v[120:121], v60 offset:4096
    ds_read_b64_tr_b16 v[122:123], v61 offset:4352
    ds_read_b64_tr_b16 v[124:125], v62 offset:9216
    ds_read_b64_tr_b16 v[126:127], v62 offset:9792
    s_waitcnt lgkmcnt(4)
    v_mfma_f32_32x32x16_bf16 v[96:111], v[112:115], v[116:119], v[96:111]
    ds_read_b64_tr_b16 v[24:25], v60 offset:5120
    ds_read_b64_tr_b16 v[26:27], v61 offset:5376
    ds_read_b64_tr_b16 v[28:29], v62 offset:11520
    ds_read_b64_tr_b16 v[30:31], v62 offset:12096
    s_waitcnt lgkmcnt(4)
    v_mfma_f32_32x32x16_bf16 v[96:111], v[120:123], v[124:127], v[96:111]
    ds_read_b64_tr_b16 v[112:113], v60 offset:6144
    ds_read_b64_tr_b16 v[114:115], v61 offset:6400
    ds_read_b64_tr_b16 v[116:117], v62 offset:13824
    ds_read_b64_tr_b16 v[118:119], v62 offset:14400
    s_waitcnt lgkmcnt(4)
    v_mfma_f32_32x32x16_bf16 v[96:111], v[24:27], v[28:31], v[96:111]
    ds_read_b64_tr_b16 v[120:121], v60 offset:7168
    ds_read_b64_tr_b16 v[122:123], v61 offset:7424
    ds_read_b64_tr_b16 v[124:125], v62 offset:16128
    ds_read_b64_tr_b16 v[126:127], v62 offset:16704
    s_waitcnt lgkmcnt(4)
    v_mfma_f32_32x32x16_bf16 v[96:111], v[112:115], v[116:119], v[96:111]
    s_waitcnt lgkmcnt(0)
    v_mfma_f32_32x32x16_bf16 v[96:111], v[120:123], v[124:127], v[96:111]
    s_nop 11
    v_cvt_pk_bf16_f32 v112, v96, v97
    v_cvt_pk_bf16_f32 v113, v98, v99
    v_cvt_pk_bf16_f32 v114, v100, v101
    v_cvt_pk_bf16_f32 v115, v102, v103
    v_cvt_pk_bf16_f32 v116, v104, v105
    v_cvt_pk_bf16_f32 v117, v106, v107
    v_cvt_pk_bf16_f32 v118, v108, v109
    v_cvt_pk_bf16_f32 v119, v110, v111
    v_permlane16_swap_b32 v112, v116
    v_permlane16_swap_b32 v113, v117
    v_permlane16_swap_b32 v114, v118
    v_permlane16_swap_b32 v115, v119
    buffer_store_dwordx4 v[112:115], v7, s[32:35], s66 offen sc1
    s_mov_b32 exec_lo, 0x00010001
    s_mov_b32 exec_hi, 0x00010001
    buffer_store_dwordx4 v[116:119], v0, s[32:35], s66 offen offset:1024 sc1
    s_mov_b64 exec, -1
    s_setprio 0
L_kv_3:
    v_mfma_f32_32x32x16_bf16 v[80:95], v[68:71], v[148:151], v[80:95]
    ds_read_b64_tr_b16 v[64:65], v20 offset:0
    ds_read_b64_tr_b16 v[66:67], v20 offset:512
    v_mfma_f32_32x32x16_bf16 v[80:95], v[72:75], v[152:155], v[80:95]
    ds_read_b64_tr_b16 v[68:69], v21 offset:0
    ds_read_b64_tr_b16 v[70:71], v21 offset:512
    s_xor_b32 s6, s71, 0
    buffer_load_dwordx4 v[132:135], v32, s[20:23], s6 offen
    v_mfma_f32_32x32x16_bf16 v[80:95], v[76:79], v[156:159], v[80:95]
    ds_read_b64_tr_b16 v[72:73], v22 offset:0
    ds_read_b64_tr_b16 v[74:75], v22 offset:512
    s_xor_b32 s6, s71, 0
    buffer_load_dwordx4 v[136:139], v33, s[20:23], s6 offen offset:1024
    s_waitcnt lgkmcnt(4)
    v_mfma_f32_16x16x32_bf16 v[48:51], v[44:47], v[64:67], v[48:51]
    v_mfma_f32_32x32x16_bf16 v[80:95], v[64:67], v[160:163], v[80:95]
    ds_read_b64_tr_b16 v[76:77], v23 offset:0
    ds_read_b64_tr_b16 v[78:79], v23 offset:512
    s_waitcnt lgkmcnt(4)
    v_mfma_f32_32x32x16_bf16 v[80:95], v[68:71], v[164:167], v[80:95]
    ds_read_b64_tr_b16 v[64:65], v20 offset:1024
    ds_read_b64_tr_b16 v[66:67], v20 offset:1536
    s_xor_b32 s6, s71, 16384
    buffer_load_dwordx4 v[140:143], v32, s[20:23], s6 offen
    s_waitcnt lgkmcnt(4)
    v_mfma_f32_32x32x16_bf16 v[80:95], v[72:75], v[168:171], v[80:95]
    ds_read_b64_tr_b16 v[68:69], v21 offset:1024
    ds_read_b64_tr_b16 v[70:71], v21 offset:1536
    s_xor_b32 s6, s71, 16384
    buffer_load_dwordx4 v[144:147], v33, s[20:23], s6 offen offset:1024
    s_waitcnt lgkmcnt(4)
    v_mfma_f32_32x32x16_bf16 v[80:95], v[76:79], v[172:175], v[80:95]
    ds_read_b64_tr_b16 v[72:73], v22 offset:1024
    ds_read_b64_tr_b16 v[74:75], v22 offset:1536
    s_waitcnt lgkmcnt(4)
    v_mfma_f32_16x16x32_bf16 v[48:51], v[44:47], v[64:67], v[48:51]
    v_mfma_f32_32x32x16_bf16 v[80:95], v[64:67], v[176:179], v[80:95]
    ds_read_b64_tr_b16 v[76:77], v23 offset:1024
    ds_read_b64_tr_b16 v[78:79], v23 offset:1536
    s_xor_b32 s6, s71, 32768
    buffer_load_dwordx4 v[148:151], v32, s[20:23], s6 offen
    s_waitcnt vmcnt(9)
    s_waitcnt lgkmcnt(0)
    s_barrier
    v_lshlrev_b32 v36, 3, v36
    v_mfma_f32_32x32x16_bf16 v[80:95], v[68:71], v[180:183], v[80:95]
    ds_read_b64_tr_b16 v[64:65], v16 offset:16384
    ds_read_b64_tr_b16 v[66:67], v16 offset:16896
    s_xor_b32 s6, s71, 32768
    buffer_load_dwordx4 v[152:155], v33, s[20:23], s6 offen offset:1024
    v_mfma_f32_32x32x16_bf16 v[80:95], v[72:75], v[184:187], v[80:95]
    ds_read_b64_tr_b16 v[68:69], v17 offset:16384
    ds_read_b64_tr_b16 v[70:71], v17 offset:16896
    s_xor_b32 s6, s71, 49152
    buffer_load_dwordx4 v[156:159], v32, s[20:23], s6 offen
    v_mfma_f32_32x32x16_bf16 v[80:95], v[76:79], v[188:191], v[80:95]
    ds_read_b64_tr_b16 v[72:73], v18 offset:16384
    ds_read_b64_tr_b16 v[74:75], v18 offset:16896
    s_xor_b32 s6, s71, 49152
    buffer_load_dwordx4 v[160:163], v33, s[20:23], s6 offen offset:1024
    s_waitcnt lgkmcnt(4)
    v_mfma_f32_16x16x32_bf16 v[48:51], v[44:47], v[64:67], v[48:51]
    v_mfma_f32_32x32x16_bf16 v[80:95], v[64:67], v[192:195], v[80:95]
    ds_read_b64_tr_b16 v[76:77], v19 offset:16384
    ds_read_b64_tr_b16 v[78:79], v19 offset:16896
    v_mov_b32 v63, s57
    s_mov_b64 exec, 1
    buffer_store_dword v63, off, s[32:35], s51 offset:0 sc1
    s_mov_b64 exec, -1
    s_add_u32 m0, s56, 0
    s_mov_b32 s6, 147456
    buffer_load_dwordx4 v32, s[20:23], s6 offen lds
    buffer_load_dwordx4 v33, s[20:23], s6 offen offset:1024 lds
    s_waitcnt lgkmcnt(4)
    v_mfma_f32_32x32x16_bf16 v[80:95], v[68:71], v[196:199], v[80:95]
    ds_read_b64_tr_b16 v[64:65], v16 offset:17408
    ds_read_b64_tr_b16 v[66:67], v16 offset:17920
    s_waitcnt lgkmcnt(4)
    v_mfma_f32_32x32x16_bf16 v[80:95], v[72:75], v[200:203], v[80:95]
    ds_read_b64_tr_b16 v[68:69], v17 offset:17408
    ds_read_b64_tr_b16 v[70:71], v17 offset:17920
    s_xor_b32 s6, s71, 65536
    buffer_load_dwordx4 v[164:167], v32, s[20:23], s6 offen
    v_and_b32 v112, 1, v0
    v_mov_b32 v113, 0x3f80
    s_waitcnt lgkmcnt(4)
    v_mfma_f32_32x32x16_bf16 v[80:95], v[76:79], v[204:207], v[80:95]
    ds_read_b64_tr_b16 v[72:73], v18 offset:17408
    ds_read_b64_tr_b16 v[74:75], v18 offset:17920
    s_xor_b32 s6, s71, 65536
    buffer_load_dwordx4 v[168:171], v33, s[20:23], s6 offen offset:1024
    v_lshlrev_b32 v112, 4, v112
    v_lshlrev_b32 v113, v112, v113
    s_waitcnt lgkmcnt(4)
    v_mfma_f32_16x16x32_bf16 v[48:51], v[44:47], v[64:67], v[48:51]
    v_mfma_f32_32x32x16_bf16 v[80:95], v[64:67], v[208:211], v[80:95]
    ds_read_b64_tr_b16 v[76:77], v19 offset:17408
    ds_read_b64_tr_b16 v[78:79], v19 offset:17920
    v_bfe_u32 v112, v0, 1, 3
    v_cmp_eq_u32 vcc, 0, v112
    v_cmp_eq_u32 s[46:47], 1, v112
    s_nop 0
    v_cndmask_b32 v24, 0, v113, vcc
    v_cndmask_b32 v25, 0, v113, s[46:47]
    s_waitcnt lgkmcnt(4)
    v_mfma_f32_32x32x16_bf16 v[80:95], v[68:71], v[212:215], v[80:95]
    ds_read_b64_tr_b16 v[64:65], v20 offset:16384
    ds_read_b64_tr_b16 v[66:67], v20 offset:16896
    s_xor_b32 s6, s71, 81920
    buffer_load_dwordx4 v[172:175], v32, s[20:23], s6 offen
    s_waitcnt lgkmcnt(4)
    v_mfma_f32_32x32x16_bf16 v[80:95], v[72:75], v[216:219], v[80:95]
    ds_read_b64_tr_b16 v[68:69], v21 offset:16384
    ds_read_b64_tr_b16 v[70:71], v21 offset:16896
    s_xor_b32 s6, s71, 81920
    buffer_load_dwordx4 v[176:179], v33, s[20:23], s6 offen offset:1024
    s_waitcnt lgkmcnt(4)
    v_mfma_f32_32x32x16_bf16 v[80:95], v[76:79], v[220:223], v[80:95]
    ds_read_b64_tr_b16 v[72:73], v22 offset:16384
    ds_read_b64_tr_b16 v[74:75], v22 offset:16896
    v_cmp_eq_u32 vcc, 2, v112
    v_cmp_eq_u32 s[46:47], 3, v112
    s_nop 0
    v_cndmask_b32 v26, 0, v113, vcc
    v_cndmask_b32 v27, 0, v113, s[46:47]
    s_waitcnt lgkmcnt(4)
    v_mfma_f32_16x16x32_bf16 v[48:51], v[44:47], v[64:67], v[48:51]
    v_mfma_f32_32x32x16_bf16 v[80:95], v[64:67], v[224:227], v[80:95]
    ds_read_b64_tr_b16 v[76:77], v23 offset:16384
    ds_read_b64_tr_b16 v[78:79], v23 offset:16896
    s_xor_b32 s6, s71, 98304
    buffer_load_dwordx4 v[180:183], v32, s[20:23], s6 offen
    s_waitcnt lgkmcnt(4)
    v_mfma_f32_32x32x16_bf16 v[80:95], v[68:71], v[228:231], v[80:95]
    ds_read_b64_tr_b16 v[64:65], v20 offset:17408
    ds_read_b64_tr_b16 v[66:67], v20 offset:17920
    s_xor_b32 s6, s71, 98304
    buffer_load_dwordx4 v[184:187], v33, s[20:23], s6 offen offset:1024
    v_cmp_eq_u32 vcc, 4, v112
    v_cmp_eq_u32 s[46:47], 5, v112
    s_nop 0
    v_cndmask_b32 v28, 0, v113, vcc
    v_cndmask_b32 v29, 0, v113, s[46:47]
    s_waitcnt lgkmcnt(4)
    v_mfma_f32_32x32x16_bf16 v[80:95], v[72:75], v[232:235], v[80:95]
    ds_read_b64_tr_b16 v[68:69], v21 offset:17408
    ds_read_b64_tr_b16 v[70:71], v21 offset:17920
    s_waitcnt lgkmcnt(4)
    v_mfma_f32_32x32x16_bf16 v[80:95], v[76:79], v[236:239], v[80:95]
    ds_read_b64_tr_b16 v[72:73], v22 offset:17408
    ds_read_b64_tr_b16 v[74:75], v22 offset:17920
    s_add_u32 m0, s56, 65536
    s_xor_b32 s6, s54, 0
    buffer_load_dwordx4 v34, s[24:27], s6 offen lds
    buffer_load_dwordx4 v35, s[24:27], s6 offen offset:1024 lds
    v_cmp_eq_u32 vcc, 6, v112
    v_cmp_eq_u32 s[46:47], 7, v112
    s_nop 0
    v_cndmask_b32 v30, 0, v113, vcc
    v_cndmask_b32 v31, 0, v113, s[46:47]
    s_waitcnt lgkmcnt(4)
    v_mfma_f32_16x16x32_bf16 v[48:51], v[44:47], v[64:67], v[48:51]
    v_mfma_f32_32x32x16_bf16 v[80:95], v[64:67], v[240:243], v[80:95]
    ds_read_b64_tr_b16 v[76:77], v23 offset:17408
    ds_read_b64_tr_b16 v[78:79], v23 offset:17920
    s_waitcnt lgkmcnt(4)
    v_mfma_f32_32x32x16_bf16 v[80:95], v[68:71], v[244:247], v[80:95]
    s_nop 2
    ds_write_b32 v14, v48 offset:1024
    s_waitcnt lgkmcnt(0)
    s_barrier
    s_cmp_lt_u32 s3, 3
    s_cbranch_scc0 L_p6_4
    s_add_u32 m0, s56, 16384
    s_mov_b32 s6, 163840
    buffer_load_dwordx4 v32, s[20:23], s6 offen lds
    buffer_load_dwordx4 v33, s[20:23], s6 offen offset:1024 lds
    s_add_u32 m0, s56, 81920
    s_mov_b32 s6, 180224
    buffer_load_dwordx4 v32, s[20:23], s6 offen lds
    buffer_load_dwordx4 v33, s[20:23], s6 offen offset:1024 lds
L_p6_4:
    s_setprio 3
    v_mfma_f32_32x32x16_bf16 v[80:95], v[72:75], v[248:251], v[80:95]
    ds_read_b128 v[44:47], v15 offset:1024
    v_mfma_f32_32x32x16_bf16 v[80:95], v[76:79], v[252:255], v[80:95]
    v_lshlrev_b32 v8, 16, v8
    s_waitcnt lgkmcnt(0)
    v_add_f32 v44, v44, v45
    v_add_f32 v46, v46, v47
    v_add_f32 v44, v44, v46
    v_cndmask_b32 v44, v8, v44, s[40:41]
    s_nop 3
    v_mfma_f32_32x32x2_f32 v[80:95], v44, v10, v[80:95]
    s_add_u32 m0, s56, 32768
    s_xor_b32 s6, s54, 16384
    buffer_load_dwordx4 v34, s[24:27], s6 offen lds
    buffer_load_dwordx4 v35, s[24:27], s6 offen offset:1024 lds
    s_nop 13
    v_pk_fma_f32 v[16:17], v[80:81], v[12:13], s[36:37] op_sel_hi:[1,0,1]
    v_pk_fma_f32 v[18:19], v[82:83], v[12:13], s[36:37] op_sel_hi:[1,0,1]
    v_pk_fma_f32 v[20:21], v[84:85], v[12:13], s[36:37] op_sel_hi:[1,0,1]
    v_pk_fma_f32 v[22:23], v[86:87], v[12:13], s[36:37] op_sel_hi:[1,0,1]
    v_exp_f32 v16, v16
    v_exp_f32 v17, v17
    s_add_u32 m0, s56, 49152
    s_xor_b32 s6, s54, 32768
    buffer_load_dwordx4 v34, s[24:27], s6 offen lds
    buffer_load_dwordx4 v35, s[24:27], s6 offen offset:1024 lds
    v_exp_f32 v18, v18
    v_exp_f32 v19, v19
    v_exp_f32 v20, v20
    v_exp_f32 v21, v21
    v_exp_f32 v22, v22
    v_exp_f32 v23, v23
    s_mov_b64 exec, s[42:43]
    buffer_load_dword v39, v36, s[32:35], s52 offen offset:0 sc1
    s_mov_b64 exec, -1
    v_pk_add_f32 v[16:17], v[16:17], s[38:39]
    s_add_u32 m0, s56, 131072
    s_xor_b32 s6, s54, 49152
    buffer_load_dwordx4 v34, s[24:27], s6 offen lds
    buffer_load_dwordx4 v35, s[24:27], s6 offen offset:1024 lds
    v_pk_add_f32 v[18:19], v[18:19], s[38:39]
    v_pk_add_f32 v[20:21], v[20:21], s[38:39]
    v_pk_add_f32 v[22:23], v[22:23], s[38:39]
    v_pk_fma_f32 v[16:17], v[16:17], v[16:17], s[36:37] neg_lo:[1,0,0] neg_hi:[1,0,0]
    v_pk_fma_f32 v[18:19], v[18:19], v[18:19], s[36:37] neg_lo:[1,0,0] neg_hi:[1,0,0]
    v_pk_fma_f32 v[20:21], v[20:21], v[20:21], s[36:37] neg_lo:[1,0,0] neg_hi:[1,0,0]
    v_pk_fma_f32 v[22:23], v[22:23], v[22:23], s[36:37] neg_lo:[1,0,0] neg_hi:[1,0,0]
    v_rcp_f32 v16, v16
    v_rcp_f32 v17, v17
    v_rcp_f32 v18, v18
    v_rcp_f32 v19, v19
    v_rcp_f32 v20, v20
    v_rcp_f32 v21, v21
    v_rcp_f32 v22, v22
    v_rcp_f32 v23, v23
    v_pk_fma_f32 v[80:81], v[80:81], v[16:17], v[80:81]
    v_pk_fma_f32 v[82:83], v[82:83], v[18:19], v[82:83]
    s_waitcnt vmcnt(2)
L_fl_5_c:
    v_cmp_ne_u32 vcc, s57, v39
    s_and_b64 vcc, vcc, s[42:43]
    s_cbranch_vccnz L_fl_5_r
L_fl_5_k:
    s_xor_b32 s7, s70, 0
    buffer_load_dwordx4 v[192:195], v37, s[32:35], s7 offen offset:0 sc1
    buffer_load_dwordx4 v[196:199], v37, s[32:35], s7 offen offset:1024 sc1
    v_pk_fma_f32 v[84:85], v[84:85], v[20:21], v[84:85]
    v_pk_fma_f32 v[86:87], v[86:87], v[22:23], v[86:87]
    v_cvt_pk_bf16_f32 v80, v80, v81
    s_xor_b32 s7, s70, 2048
    buffer_load_dwordx4 v[200:203], v37, s[32:35], s7 offen offset:0 sc1
    buffer_load_dwordx4 v[204:207], v37, s[32:35], s7 offen offset:1024 sc1
    v_cvt_pk_bf16_f32 v81, v82, v83
    v_cvt_pk_bf16_f32 v82, v84, v85
    v_cvt_pk_bf16_f32 v83, v86, v87
    buffer_store_dwordx4 v[80:83], v9, s[32:35], s68 offen offset:0 sc1
    s_xor_b32 s7, s70, 4096
    buffer_load_dwordx4 v[208:211], v37, s[32:35], s7 offen offset:0 sc1
    buffer_load_dwordx4 v[212:215], v37, s[32:35], s7 offen offset:1024 sc1
    v_pk_fma_f32 v[16:17], v[88:89], v[12:13], s[36:37] op_sel_hi:[1,0,1]
    v_pk_fma_f32 v[18:19], v[90:91], v[12:13], s[36:37] op_sel_hi:[1,0,1]
    v_pk_fma_f32 v[20:21], v[92:93], v[12:13], s[36:37] op_sel_hi:[1,0,1]
    s_lshr_b32 s59, s56, 1
    s_sub_u32 s60, 155648, s59
    s_xor_b32 s7, s70, 6144
    buffer_load_dwordx4 v[248:251], v37, s[32:35], s7 offen offset:0 sc1
    buffer_load_dwordx4 v[252:255], v37, s[32:35], s7 offen offset:1024 sc1
    v_pk_fma_f32 v[22:23], v[94:95], v[12:13], s[36:37] op_sel_hi:[1,0,1]
    s_add_u32 s59, s59, 155648
    v_exp_f32 v16, v16
    v_add_u32 v38, s59, v7
    v_exp_f32 v17, v17
    v_add_u32 v56, s60, v1
    v_exp_f32 v18, v18
    v_add_u32 v57, s60, v2
    v_exp_f32 v19, v19
    v_exp_f32 v20, v20
    ds_write_b128 v38, v[132:135]
    v_exp_f32 v21, v21
    ds_read_b64_tr_b16 v[128:129], v56
    v_exp_f32 v22, v22
    ds_read_b64_tr_b16 v[132:133], v57
    v_exp_f32 v23, v23
    ds_write_b128 v38, v[136:139]
    v_pk_add_f32 v[16:17], v[16:17], s[38:39]
    ds_read_b64_tr_b16 v[130:131], v56
    ds_read_b64_tr_b16 v[134:135], v57
    v_pk_add_f32 v[18:19], v[18:19], s[38:39]
    v_pk_add_f32 v[20:21], v[20:21], s[38:39]
    ds_write_b128 v38, v[140:143]
    v_pk_add_f32 v[22:23], v[22:23], s[38:39]
    ds_read_b64_tr_b16 v[136:137], v56
    v_pk_fma_f32 v[16:17], v[16:17], v[16:17], s[36:37] neg_lo:[1,0,0] neg_hi:[1,0,0]
    ds_read_b64_tr_b16 v[140:141], v57
    v_pk_fma_f32 v[18:19], v[18:19], v[18:19], s[36:37] neg_lo:[1,0,0] neg_hi:[1,0,0]
    ds_write_b128 v38, v[144:147]
    v_pk_fma_f32 v[20:21], v[20:21], v[20:21], s[36:37] neg_lo:[1,0,0] neg_hi:[1,0,0]
    ds_read_b64_tr_b16 v[138:139], v56
    v_pk_fma_f32 v[22:23], v[22:23], v[22:23], s[36:37] neg_lo:[1,0,0] neg_hi:[1,0,0]
    ds_read_b64_tr_b16 v[142:143], v57
    v_rcp_f32 v16, v16
    v_rcp_f32 v17, v17
    ds_write_b128 v38, v[148:151]
    v_rcp_f32 v18, v18
    ds_read_b64_tr_b16 v[144:145], v56
    ds_read_b64_tr_b16 v[148:149], v57
    v_rcp_f32 v19, v19
    ds_write_b128 v38, v[152:155]
    v_rcp_f32 v20, v20
    ds_read_b64_tr_b16 v[146:147], v56
    v_rcp_f32 v21, v21
    ds_read_b64_tr_b16 v[150:151], v57
    v_rcp_f32 v22, v22
    v_rcp_f32 v23, v23
    ds_write_b128 v38, v[156:159]
    v_pk_fma_f32 v[88:89], v[88:89], v[16:17], v[88:89]
    ds_read_b64_tr_b16 v[152:153], v56
    v_pk_fma_f32 v[90:91], v[90:91], v[18:19], v[90:91]
    ds_read_b64_tr_b16 v[156:157], v57
    v_pk_fma_f32 v[92:93], v[92:93], v[20:21], v[92:93]
    ds_write_b128 v38, v[160:163]
    v_pk_fma_f32 v[94:95], v[94:95], v[22:23], v[94:95]
    ds_read_b64_tr_b16 v[154:155], v56
    v_cvt_pk_bf16_f32 v84, v88, v89
    ds_read_b64_tr_b16 v[158:159], v57
    v_cvt_pk_bf16_f32 v85, v90, v91
    ds_write_b128 v38, v[164:167]
    v_cvt_pk_bf16_f32 v86, v92, v93
    ds_read_b64_tr_b16 v[160:161], v56
    v_cvt_pk_bf16_f32 v87, v94, v95
    ds_read_b64_tr_b16 v[164:165], v57
    buffer_store_dwordx4 v[84:87], v9, s[32:35], s68 offen offset:2048 sc1
    ds_write_b128 v38, v[168:171]
    s_setprio 0
    ds_read_b64_tr_b16 v[162:163], v56
    ds_read_b64_tr_b16 v[166:167], v57
    v_bfe_u32 v22, v0, 2, 2
    v_lshrrev_b32 v23, 5, v0
    ds_write_b128 v38, v[172:175]
    s_xor_b32 s7, s70, 8192
    buffer_load_dwordx4 v[216:219], v37, s[32:35], s7 offen offset:0 sc1
    buffer_load_dwordx4 v[220:223], v37, s[32:35], s7 offen offset:1024 sc1
    v_lshl_add_u32 v23, v23, 2, v22
    ds_read_b64_tr_b16 v[168:169], v56
    v_lshlrev_b32 v9, 4, v23
    ds_read_b64_tr_b16 v[172:173], v57
    ds_write_b128 v38, v[176:179]
    v_and_b32 v8, 16, v0
    ds_read_b64_tr_b16 v[170:171], v56
    s_xor_b32 s7, s70, 10240
    buffer_load_dwordx4 v[224:227], v37, s[32:35], s7 offen offset:0 sc1
    buffer_load_dwordx4 v[228:231], v37, s[32:35], s7 offen offset:1024 sc1
    v_lshlrev_b32 v8, 2, v8
    ds_read_b64_tr_b16 v[174:175], v57
    v_lshl_add_u32 v8, v23, 10, v8
    v_and_b32 v23, 3, v0
    ds_write_b128 v38, v[180:183]
    s_xor_b32 s7, s70, 12288
    buffer_load_dwordx4 v[232:235], v37, s[32:35], s7 offen offset:0 sc1
    buffer_load_dwordx4 v[236:239], v37, s[32:35], s7 offen offset:1024 sc1
    v_lshl_add_u32 v8, v23, 4, v8
    ds_read_b64_tr_b16 v[176:177], v56
    v_add_u32 v20, s56, v7
    ds_read_b64_tr_b16 v[180:181], v57
    s_lshl_b32 s59, s5, 16
    ds_write_b128 v38, v[184:187]
    s_xor_b32 s7, s70, 14336
    buffer_load_dwordx4 v[240:243], v37, s[32:35], s7 offen offset:0 sc1
    buffer_load_dwordx4 v[244:247], v37, s[32:35], s7 offen offset:1024 sc1
    s_lshl_b32 s60, s4, 7
    ds_read_b64_tr_b16 v[178:179], v56
    s_add_u32 s59, s59, s60
    ds_read_b64_tr_b16 v[182:183], v57
    v_lshl_add_u32 v21, v22, 4, s59
    v_and_b32 v22, 1, v0
    v_mul_u32_u24 v22, 16448, v22
    v_bfe_u32 v23, v0, 1, 1
    v_mul_u32_u24 v23, 32896, v23
    v_add3_u32 v21, v21, v22, v23
    v_lshrrev_b32 v22, 4, v0
    v_lshl_add_u32 v21, v22, 11, v21
    v_add_u32 v23, 0x10000, v20
    buffer_load_dwordx2 v[14:15], v9, s[32:35], s73 offen offset:8 sc1
    buffer_load_dwordx4 v[16:19], v8, s[8:11], s69 offen
    s_waitcnt vmcnt(18) lgkmcnt(15)
    v_mfma_f32_32x32x16_bf16 v[64:79], v[128:131], v[192:195], 0
    v_mfma_f32_32x32x16_bf16 v[80:95], v[132:135], v[192:195], 0
    v_mfma_f32_32x32x16_bf16 v[96:111], v[128:131], v[196:199], 0
    v_mfma_f32_32x32x16_bf16 v[112:127], v[132:135], v[196:199], 0
    s_waitcnt vmcnt(16)
    v_mfma_f32_32x32x16_bf16 v[64:79], v[136:139], v[200:203], v[64:79]
    s_or_b32 s59, s2, s3
    s_cmp_eq_u32 s59, 0
    s_cbranch_scc0 L_ep_6
    v_lshlrev_b32 v38, 7, v0
    s_mov_b32 s59, 4096
    buffer_load_dword v10, v38, s[32:35], s59 offen offset:12 sc1
    s_mov_b32 s59, 12288
    buffer_load_dword v11, v38, s[32:35], s59 offen offset:12 sc1
    s_mov_b32 s59, 20480
    buffer_load_dword v12, v38, s[32:35], s59 offen offset:12 sc1
    s_mov_b32 s59, 28672
    buffer_load_dword v13, v38, s[32:35], s59 offen offset:12 sc1
L_ep_6:
    v_mfma_f32_32x32x16_bf16 v[80:95], v[140:143], v[200:203], v[80:95]
    ds_read_b64_tr_b16 v[128:129], v3 offset:32768
    v_mfma_f32_32x32x16_bf16 v[96:111], v[136:139], v[204:207], v[96:111]
    ds_read_b64_tr_b16 v[130:131], v3 offset:33792
    ds_read_b64_tr_b16 v[132:133], v4 offset:32768
    v_mfma_f32_32x32x16_bf16 v[112:127], v[140:143], v[204:207], v[112:127]
    ds_read_b64_tr_b16 v[134:135], v4 offset:33792
    s_waitcnt vmcnt(13)
    v_mfma_f32_32x32x16_bf16 v[64:79], v[144:147], v[208:211], v[64:79]
    ds_read_b64_tr_b16 v[136:137], v3 offset:49152
    v_mfma_f32_32x32x16_bf16 v[80:95], v[148:151], v[208:211], v[80:95]
    ds_read_b64_tr_b16 v[138:139], v3 offset:50176
    v_mfma_f32_32x32x16_bf16 v[96:111], v[144:147], v[212:215], v[96:111]
    ds_read_b64_tr_b16 v[140:141], v4 offset:49152
    v_mfma_f32_32x32x16_bf16 v[112:127], v[148:151], v[212:215], v[112:127]
    ds_read_b64_tr_b16 v[142:143], v4 offset:50176
    s_waitcnt vmcnt(11)
    v_mfma_f32_32x32x16_bf16 v[64:79], v[152:155], v[248:251], v[64:79]
    ds_read_b64_tr_b16 v[144:145], v1 offset:0
    v_mfma_f32_32x32x16_bf16 v[80:95], v[156:159], v[248:251], v[80:95]
    ds_read_b64_tr_b16 v[146:147], v1 offset:1024
    v_mfma_f32_32x32x16_bf16 v[96:111], v[152:155], v[252:255], v[96:111]
    ds_read_b64_tr_b16 v[148:149], v2 offset:0
    v_mfma_f32_32x32x16_bf16 v[112:127], v[156:159], v[252:255], v[112:127]
    ds_read_b64_tr_b16 v[150:151], v2 offset:1024
    s_waitcnt vmcnt(8) lgkmcnt(15)
    v_mfma_f32_32x32x16_bf16 v[64:79], v[160:163], v[216:219], v[64:79]
    s_cmp_lt_u32 s3, 3
    s_cbranch_scc0 L_p6_7
    s_movk_i32 s7, 20480
    buffer_load_dwordx4 v[48:51], v37, s[32:35], s7 offen offset:0 sc1
    buffer_load_dwordx4 v[52:55], v37, s[32:35], s7 offen offset:1024 sc1
    s_movk_i32 s7, 22528
    buffer_load_dwordx4 v[56:59], v37, s[32:35], s7 offen offset:0 sc1
    buffer_load_dwordx4 v[60:63], v37, s[32:35], s7 offen offset:1024 sc1
L_p6_7:
    v_mfma_f32_32x32x16_bf16 v[80:95], v[164:167], v[216:219], v[80:95]
    s_movk_i32 s7, 16384
    buffer_load_dwordx4 v[184:187], v37, s[32:35], s7 offen offset:0 sc1
    buffer_load_dwordx4 v[188:191], v37, s[32:35], s7 offen offset:1024 sc1
    v_mfma_f32_32x32x16_bf16 v[96:111], v[160:163], v[220:223], v[96:111]
    s_movk_i32 s7, 18432
    buffer_load_dwordx4 v[40:43], v37, s[32:35], s7 offen offset:0 sc1
    buffer_load_dwordx4 v[44:47], v37, s[32:35], s7 offen offset:1024 sc1
    v_mfma_f32_32x32x16_bf16 v[112:127], v[164:167], v[220:223], v[112:127]
    s_waitcnt vmcnt(10)
    v_mfma_f32_32x32x16_bf16 v[64:79], v[168:171], v[224:227], v[64:79]
    s_cmp_lt_u32 s3, 3
    s_cbranch_scc0 L_p6_8
    ds_read_b64_tr_b16 v[152:153], v1 offset:16384
    ds_read_b64_tr_b16 v[154:155], v1 offset:17408
    ds_read_b64_tr_b16 v[156:157], v2 offset:16384
    ds_read_b64_tr_b16 v[158:159], v2 offset:17408
    ds_read_b64_tr_b16 v[160:161], v3 offset:16384
    ds_read_b64_tr_b16 v[162:163], v3 offset:17408
    ds_read_b64_tr_b16 v[164:165], v4 offset:16384
    ds_read_b64_tr_b16 v[166:167], v4 offset:17408
L_p6_8:
    v_mfma_f32_32x32x16_bf16 v[80:95], v[172:175], v[224:227], v[80:95]
    v_mfma_f32_32x32x16_bf16 v[96:111], v[168:171], v[228:231], v[96:111]
    v_mfma_f32_32x32x16_bf16 v[112:127], v[172:175], v[228:231], v[112:127]
    s_waitcnt vmcnt(8) lgkmcnt(12)
    v_mfma_f32_32x32x16_bf16 v[64:79], v[176:179], v[232:235], v[64:79]
    ds_read_b64_tr_b16 v[168:169], v3 offset:0
    v_mfma_f32_32x32x16_bf16 v[80:95], v[180:183], v[232:235], v[80:95]
    ds_read_b64_tr_b16 v[170:171], v3 offset:1024
    v_mfma_f32_32x32x16_bf16 v[96:111], v[176:179], v[236:239], v[96:111]
    ds_read_b64_tr_b16 v[172:173], v4 offset:0
    v_mfma_f32_32x32x16_bf16 v[112:127], v[180:183], v[236:239], v[112:127]
    ds_read_b64_tr_b16 v[174:175], v4 offset:1024
    s_waitcnt vmcnt(6) lgkmcnt(12)
    v_mfma_f32_32x32x16_bf16 v[64:79], v[128:131], v[240:243], v[64:79]
    ds_read_b64_tr_b16 v[176:177], v1 offset:32768
    v_mfma_f32_32x32x16_bf16 v[80:95], v[132:135], v[240:243], v[80:95]
    ds_read_b64_tr_b16 v[178:179], v1 offset:33792
    v_mfma_f32_32x32x16_bf16 v[96:111], v[128:131], v[244:247], v[96:111]
    ds_read_b64_tr_b16 v[180:181], v2 offset:32768
    v_mfma_f32_32x32x16_bf16 v[112:127], v[132:135], v[244:247], v[112:127]
    ds_read_b64_tr_b16 v[182:183], v2 offset:33792
    s_waitcnt vmcnt(0)
L_s_9_c:
    v_max3_u32 v22, v184, v188, v40
    v_max_u32 v22, v22, v44
    v_cmp_eq_u32 vcc, -1, v22
    s_cbranch_vccnz L_s_9_r
L_s_9_k:
    s_waitcnt lgkmcnt(12)
    v_mfma_f32_32x32x16_bf16 v[64:79], v[136:139], v[184:187], v[64:79]
    ds_read_b64_tr_b16 v[128:129], v1 offset:49152
    v_mfma_f32_32x32x16_bf16 v[80:95], v[140:143], v[184:187], v[80:95]
    ds_read_b64_tr_b16 v[130:131], v1 offset:50176
    v_mfma_f32_32x32x16_bf16 v[96:111], v[136:139], v[188:191], v[96:111]
    ds_read_b64_tr_b16 v[132:133], v2 offset:49152
    v_mfma_f32_32x32x16_bf16 v[112:127], v[140:143], v[188:191], v[112:127]
    ds_read_b64_tr_b16 v[134:135], v2 offset:50176
    s_waitcnt lgkmcnt(12)
    v_mfma_f32_32x32x16_bf16 v[64:79], v[144:147], v[40:43], v[64:79]
    s_xor_b32 s7, s53, 0
    s_add_u32 s7, s72, s7
    buffer_load_dwordx4 v[192:195], v37, s[32:35], s7 offen offset:0 sc1
    s_xor_b32 s7, s53, 2048
    s_add_u32 s7, s72, s7
    buffer_load_dwordx4 v[200:203], v37, s[32:35], s7 offen offset:0 sc1
    s_xor_b32 s7, s53, 4096
    s_add_u32 s7, s72, s7
    buffer_load_dwordx4 v[208:211], v37, s[32:35], s7 offen offset:0 sc1
    v_mfma_f32_32x32x16_bf16 v[80:95], v[148:151], v[40:43], v[80:95]
    s_xor_b32 s7, s53, 6144
    s_add_u32 s7, s72, s7
    buffer_load_dwordx4 v[248:251], v37, s[32:35], s7 offen offset:0 sc1
    s_xor_b32 s7, s53, 0
    s_add_u32 s7, s72, s7
    buffer_load_dwordx4 v[196:199], v37, s[32:35], s7 offen offset:1024 sc1
    v_mfma_f32_32x32x16_bf16 v[96:111], v[144:147], v[44:47], v[96:111]
    s_xor_b32 s7, s53, 2048
    s_add_u32 s7, s72, s7
    buffer_load_dwordx4 v[204:207], v37, s[32:35], s7 offen offset:1024 sc1
    s_xor_b32 s7, s53, 4096
    s_add_u32 s7, s72, s7
    buffer_load_dwordx4 v[212:215], v37, s[32:35], s7 offen offset:1024 sc1
    s_xor_b32 s7, s53, 6144
    s_add_u32 s7, s72, s7
    buffer_load_dwordx4 v[252:255], v37, s[32:35], s7 offen offset:1024 sc1
    v_mfma_f32_32x32x16_bf16 v[112:127], v[148:151], v[44:47], v[112:127]
    ds_read_b64_tr_b16 v[136:137], v5 offset:0
    ds_read_b64_tr_b16 v[138:139], v5 offset:1024
    ds_read_b64_tr_b16 v[140:141], v6 offset:0
    ds_read_b64_tr_b16 v[142:143], v6 offset:1024
    s_waitcnt lgkmcnt(12)
    s_cmp_lt_u32 s3, 3
    s_cbranch_scc0 L_p6_10
L_s_11_c:
    v_max3_u32 v22, v48, v52, v56
    v_max_u32 v22, v22, v60
    v_cmp_eq_u32 vcc, -1, v22
    s_cbranch_vccnz L_s_11_r
L_s_11_k:
    v_mfma_f32_32x32x16_bf16 v[64:79], v[152:155], v[48:51], v[64:79]
    v_mfma_f32_32x32x16_bf16 v[80:95], v[156:159], v[48:51], v[80:95]
    v_mfma_f32_32x32x16_bf16 v[96:111], v[152:155], v[52:55], v[96:111]
    v_mfma_f32_32x32x16_bf16 v[112:127], v[156:159], v[52:55], v[112:127]
    v_mfma_f32_32x32x16_bf16 v[64:79], v[160:163], v[56:59], v[64:79]
    v_mfma_f32_32x32x16_bf16 v[80:95], v[164:167], v[56:59], v[80:95]
    v_mfma_f32_32x32x16_bf16 v[96:111], v[160:163], v[60:63], v[96:111]
    v_mfma_f32_32x32x16_bf16 v[112:127], v[164:167], v[60:63], v[112:127]
L_p6_10:
    s_waitcnt vmcnt(4) lgkmcnt(0)
L_s_12_c:
    v_max3_u32 v22, v192, v200, v208
    v_max_u32 v22, v22, v248
    v_cmp_eq_u32 vcc, -1, v22
    s_cbranch_vccnz L_s_12_r
L_s_12_k:
L_rs_13_c:
    v_cmp_ne_u32 vcc, s57, v15
    s_cbranch_vccnz L_rs_13_r
L_rs_13_k:
    v_mfma_f32_32x32x16_bf16 v[64:79], v[168:171], v[192:195], v[64:79]
    v_lshlrev_b32 v216, 16, v16
    v_mfma_f32_32x32x16_bf16 v[80:95], v[172:175], v[192:195], v[80:95]
    v_and_b32 v217, s44, v16
    v_mfma_f32_32x32x16_bf16 v[64:79], v[176:179], v[200:203], v[64:79]
    v_lshlrev_b32 v218, 16, v17
    v_mfma_f32_32x32x16_bf16 v[80:95], v[180:183], v[200:203], v[80:95]
    v_and_b32 v219, s44, v17
    v_mfma_f32_32x32x16_bf16 v[64:79], v[128:131], v[208:211], v[64:79]
    v_lshlrev_b32 v220, 16, v18
    v_mfma_f32_32x32x16_bf16 v[80:95], v[132:135], v[208:211], v[80:95]
    v_and_b32 v221, s44, v18
    v_mfma_f32_32x32x16_bf16 v[64:79], v[136:139], v[248:251], v[64:79]
    v_lshlrev_b32 v222, 16, v19
    v_mfma_f32_32x32x16_bf16 v[80:95], v[140:143], v[248:251], v[80:95]
    v_and_b32 v223, s44, v19
    s_waitcnt vmcnt(0)
L_s_14_c:
    v_max3_u32 v22, v196, v204, v212
    v_max_u32 v22, v22, v252
    v_cmp_eq_u32 vcc, -1, v22
    s_cbranch_vccnz L_s_14_r
L_s_14_k:
    v_mfma_f32_32x32x16_bf16 v[96:111], v[168:171], v[196:199], v[96:111]
    v_mfma_f32_32x32x16_bf16 v[112:127], v[172:175], v[196:199], v[112:127]
    s_nop 1
    v_cvt_pk_bf16_f32 v64, v64, v65
    v_cvt_pk_bf16_f32 v65, v66, v67
    v_cvt_pk_bf16_f32 v66, v80, v81
    v_cvt_pk_bf16_f32 v67, v82, v83
    v_mfma_f32_32x32x16_bf16 v[96:111], v[176:179], v[204:207], v[96:111]
    ds_write_b128 v20, v[64:67] offset:0
    v_cvt_pk_bf16_f32 v68, v68, v69
    v_mfma_f32_32x32x16_bf16 v[112:127], v[180:183], v[204:207], v[112:127]
    v_cvt_pk_bf16_f32 v69, v70, v71
    v_cvt_pk_bf16_f32 v70, v84, v85
    v_cvt_pk_bf16_f32 v71, v86, v87
    ds_write_b128 v20, v[68:71] offset:16448
    v_mfma_f32_32x32x16_bf16 v[96:111], v[128:131], v[212:215], v[96:111]
    v_cvt_pk_bf16_f32 v72, v72, v73
    v_cvt_pk_bf16_f32 v73, v74, v75
    v_mfma_f32_32x32x16_bf16 v[112:127], v[132:135], v[212:215], v[112:127]
    v_cvt_pk_bf16_f32 v74, v88, v89
    v_cvt_pk_bf16_f32 v75, v90, v91
    ds_write_b128 v20, v[72:75] offset:32896
    v_mfma_f32_32x32x16_bf16 v[96:111], v[136:139], v[252:255], v[96:111]
    v_cvt_pk_bf16_f32 v76, v76, v77
    v_cvt_pk_bf16_f32 v77, v78, v79
    v_cvt_pk_bf16_f32 v78, v92, v93
    v_mfma_f32_32x32x16_bf16 v[112:127], v[140:143], v[252:255], v[112:127]
    v_cvt_pk_bf16_f32 v79, v94, v95
    ds_write_b128 v20, v[76:79] offset:49344
    s_or_b32 s59, s2, s3
    s_cmp_eq_u32 s59, 0
    s_nop 4
    s_cbranch_scc0 L_ep_15
L_epc_16_c:
    v_xor_b32 v10, s57, v10
    v_xor_b32 v11, s57, v11
    v_xor_b32 v12, s57, v12
    v_xor_b32 v13, s57, v13
    v_or3_b32 v10, v10, v11, v12
    v_or_b32 v10, v10, v13
    v_cmp_ne_u32 vcc, 0, v10
    s_cbranch_vccnz L_epc_16_r
L_epc_16_k:
    v_mov_b32 v10, s57
    s_mov_b64 exec, 1
    buffer_store_dword v10, off, s[32:35], 0 sc1
    s_mov_b64 exec, -1
L_ep_15:
    v_cvt_pk_bf16_f32 v96, v96, v97
    v_cvt_pk_bf16_f32 v97, v98, v99
    v_cvt_pk_bf16_f32 v98, v112, v113
    v_cvt_pk_bf16_f32 v99, v114, v115
    ds_write_b128 v23, v[96:99] offset:0
    v_cvt_pk_bf16_f32 v100, v100, v101
    v_cvt_pk_bf16_f32 v101, v102, v103
    v_cvt_pk_bf16_f32 v102, v116, v117
    v_cvt_pk_bf16_f32 v103, v118, v119
    ds_write_b128 v23, v[100:103] offset:16448
    v_cvt_pk_bf16_f32 v104, v104, v105
    v_cvt_pk_bf16_f32 v105, v106, v107
    v_cvt_pk_bf16_f32 v106, v120, v121
    v_cvt_pk_bf16_f32 v107, v122, v123
    ds_write_b128 v23, v[104:107] offset:32896
    v_cvt_pk_bf16_f32 v108, v108, v109
    v_cvt_pk_bf16_f32 v109, v110, v111
    v_cvt_pk_bf16_f32 v110, v124, v125
    v_cvt_pk_bf16_f32 v111, v126, v127
    ds_write_b128 v23, v[108:111] offset:49344
    s_waitcnt lgkmcnt(0)
    s_barrier
    ds_read_b128 v[224:227], v21 offset:0
    ds_read_b128 v[228:231], v21 offset:8192
    ds_read_b128 v[232:235], v21 offset:64
    ds_read_b128 v[236:239], v21 offset:8256
    ds_read_b128 v[240:243], v21 offset:512
    ds_read_b128 v[244:247], v21 offset:8704
    ds_read_b128 v[248:251], v21 offset:576
    ds_read_b128 v[252:255], v21 offset:8768
    s_waitcnt lgkmcnt(7)
    v_mfma_f32_16x16x32_bf16 v[128:131], v[24:27], v[224:227], 0
    s_waitcnt lgkmcnt(6)
    v_mfma_f32_16x16x32_bf16 v[128:131], v[24:27], v[228:231], v[128:131]
    s_waitcnt lgkmcnt(3)
    v_mfma_f32_16x16x32_bf16 v[132:135], v[24:27], v[240:243], 0
    s_waitcnt lgkmcnt(2)
    v_mfma_f32_16x16x32_bf16 v[132:135], v[24:27], v[244:247], v[132:135]
    v_mfma_f32_16x16x32_bf16 v[128:131], v[28:31], v[232:235], v[128:131]
    v_mfma_f32_16x16x32_bf16 v[128:131], v[28:31], v[236:239], v[128:131]
    s_waitcnt lgkmcnt(1)
    v_mfma_f32_16x16x32_bf16 v[132:135], v[28:31], v[248:251], v[132:135]
    s_waitcnt lgkmcnt(0)
    v_mfma_f32_16x16x32_bf16 v[132:135], v[28:31], v[252:255], v[132:135]
    s_nop 3
    v_pk_fma_f32 v[128:129], v[128:129], v[14:15], v[216:217] op_sel_hi:[1,0,1]
    v_pk_fma_f32 v[130:131], v[130:131], v[14:15], v[218:219] op_sel_hi:[1,0,1]
    s_nop 1
    v_pk_fma_f32 v[132:133], v[132:133], v[14:15], v[220:221] op_sel_hi:[1,0,1]
    v_pk_fma_f32 v[134:135], v[134:135], v[14:15], v[222:223] op_sel_hi:[1,0,1]
    v_cvt_pk_bf16_f32 v136, v128, v129
    v_cvt_pk_bf16_f32 v137, v130, v131
    v_cvt_pk_bf16_f32 v138, v132, v133
    v_cvt_pk_bf16_f32 v139, v134, v135
    buffer_store_dwordx4 v[136:139], v8, s[28:31], s69 offen sc1 nt
    s_branch L_fin
L_B:
    s_load_dwordx2 s[36:37], s[0:1], 16
    s_load_dwordx2 s[40:41], s[0:1], 48
    s_load_dwordx2 s[20:21], s[0:1], 56
    s_load_dwordx2 s[24:25], s[0:1], 24
    s_load_dwordx2 s[28:29], s[0:1], 64
    s_and_b32 s4, s3, 3
    v_and_b32 v28, 31, v0
    s_xor_b32 s60, s4, s5
    v_lshrrev_b32 v29, 5, v0
    v_bfe_u32 v30, v0, 1, 3
    s_lshl_b32 s59, s4, 7
    v_xor_b32 v30, v29, v30
    s_add_u32 s59, s59, s60
    v_lshlrev_b32 v30, 4, v30
    s_lshl_b32 s59, s59, 5
    v_lshl_add_u32 v30, v28, 7, v30
    v_bfe_u32 v24, v0, 2, 2
    v_xor_b32 v40, s59, v30
    v_bfe_u32 v25, v0, 4, 1
    v_xor_b32 v41, 32, v40
    v_and_b32 v26, 3, v0
    v_xor_b32 v42, 64, v40
    v_lshlrev_b32 v26, 3, v26
    v_xor_b32 v43, 96, v40
    v_lshl_add_u32 v26, v25, 5, v26
    v_lshrrev_b32 v30, 1, v24
    s_lshl_b32 s59, s60, 6
    v_lshl_add_u32 v30, v30, 6, v26
    s_add_u32 s59, s59, s5
    v_lshl_add_u32 v27, v24, 7, v30
    s_lshl_b32 s59, s59, 6
    v_lshl_add_u32 v30, v29, 11, v27
    s_or_b32 s59, s59, 0x10000
    v_xor_b32 v31, v24, v25
    v_xor_b32 v20, s59, v30
    v_and_b32 v31, 1, v31
    v_xor_b32 v21, 4096, v20
    v_cmp_eq_u32 vcc, 0, v31
    v_xor_b32 v22, 8192, v20
    v_mov_b32 v31, 0x3f803f80
    v_xor_b32 v23, 12288, v20
    v_cndmask_b32 v44, 0, v31, vcc
    v_cndmask_b32 v45, 0, v31, vcc
    v_cndmask_b32 v46, 0, v31, vcc
    v_cndmask_b32 v47, 0, v31, vcc
    s_add_u32 s50, s64, s5
    s_and_b32 s59, s2, 7
    s_bfe_u32 s60, s2, 0x20003
    s_lshl2_add_u32 s74, s59, s60
    s_lshr_b32 s75, s2, 5
    s_xor_b32 s75, s75, 2
    s_mov_b32 s22, 1409024
    s_mov_b32 s23, 0x00020000
    s_mov_b32 s26, 524288
    s_mov_b32 s27, 0x00020000
    s_lshl3_add_u32 s59, s2, s3
    s_lshl_b32 s59, s59, 10
    v_lshl_add_u32 v252, v0, 7, s59
    v_add_u32 v253, 0xffea8000, v252
    s_lshl_b32 s60, s60, 1
    s_xor_b32 s60, s60, s75
    s_and_b32 s60, s60, 7
    s_lshl_b32 s70, s60, 11
    s_lshl_b32 s71, s60, 14
    s_lshr_b32 s60, s60, 1
    s_lshl_b32 s53, s60, 11
    s_lshl_b32 s54, s60, 14
    s_lshl1_add_u32 s76, s4, s5
    s_mul_i32 s65, s76, 11
    s_add_u32 s65, s65, 1
    s_lshr_b32 s65, s65, 1
    s_min_u32 s65, s65, 38
    v_and_b32 v31, 7, v248
    v_lshl_add_u32 v31, v31, 10, v249
    s_lshl_b32 s59, s65, 8
    s_add_u32 s59, s59, s75
    s_lshl_b32 s59, s59, 7
    v_add_u32 v32, s59, v31
    v_add_u32 v33, 7168, v32
    s_lshl_b32 s59, s76, 9
    s_add_u32 s59, s59, s75
    s_lshl_b32 s59, s59, 7
    v_add_u32 v34, s59, v31
    v_add_u32 v35, 7168, v34
    s_mul_i32 s59, s74, 59
    s_add_u32 s59, s59, s65
    s_lshl_b32 s59, s59, 12
    s_add_u32 s59, s59, 1310720
    v_add_u32 v37, s59, v7
    s_lshl1_add_u32 s60, s76, 43
    s_sub_u32 s60, s60, s65
    s_lshl_b32 s72, s60, 12
    s_mov_b32 s18, 1572864
    s_mov_b32 s19, 0x00020000
    s_lshl_b32 s59, s63, 7
    v_mul_u32_u24 v5, 3072, v248
    v_add3_u32 v5, v5, v249, s59
    v_lshlrev_b32 v8, 1, v28
    s_lshl4_add_u32 s77, s77, 4096
    s_lshl2_add_u32 s59, s62, s4
    s_lshl_b32 s59, s59, 9
    s_add_u32 s59, s59, 4096
    v_lshl_add_u32 v6, v28, 4, s59
    s_lshl_b32 s59, s5, 9
    s_add_u32 s59, s59, 151552
    v_lshl_add_u32 v15, v28, 4, s59
    s_lshl_b32 s59, s4, 2
    v_add_u32 v14, s59, v15
    v_lshl_add_u32 v27, v29, 9, v27
    v_add_u32 v38, s56, v27
    v_lshl_add_u32 v31, v29, 2, v24
    v_lshlrev_b32 v31, 5, v31
    v_lshl_add_u32 v31, v25, 4, v31
    v_bfe_u32 v27, v0, 1, 1
    v_lshl_add_u32 v31, v27, 3, v31
    s_lshl_b32 s59, s5, 10
    s_add_u32 s59, s59, 149504
    v_add_u32 v56, s59, v31
    v_bfe_i32 v57, v0, 2, 1
    v_and_b32 v57, 0x80008000, v57
    v_and_b32 v16, 0xffff, v20
    v_and_b32 v17, 0xffff, v21
    v_and_b32 v18, 0xffff, v22
    v_and_b32 v19, 0xffff, v23
    s_lshr_b32 s59, s74, 1
    s_lshl4_add_u32 s59, s59, s76
    s_lshl_b32 s59, s59, 7
    s_add_u32 s59, s59, 4096
    v_and_b32 v31, 8, v0
    v_mul_u32_u24 v31, 0x70, v31
    v_and_b32 v30, 15, v0
    v_lshl_add_u32 v31, v30, 4, v31
    v_add_u32 v36, s59, v31
    s_lshl2_add_u32 s59, s63, s4
    s_mul_i32 s59, s59, 18432
    s_add_u32 s59, s59, 131072
    v_lshrrev_b32 v31, 4, v0
    v_mul_u32_u24 v31, 1152, v31
    v_add_u32 v31, s59, v31
    s_lshl_b32 s60, s5, 9
    v_lshlrev_b32 v26, 4, v30
    v_add3_u32 v58, v31, v26, s60
    v_bfe_u32 v59, v0, 1, 2
    v_mul_u32_u24 v59, 4608, v59
    v_and_b32 v27, 1, v0
    v_lshl_add_u32 v31, v27, 4, v31
    s_lshl_b32 s60, s5, 5
    v_add3_u32 v59, v59, v31, s60
    s_lshl3_add_u32 s59, s63, s4
    s_lshl4_add_u32 s59, s59, 4096
    s_add_u32 m0, s56, 16384
    s_add_u32 s6, s61, 128
    s_and_b32 s6, s6, 0x380
    buffer_load_dwordx4 v1, s[8:11], s6 offen lds
    v_lshl_add_u32 v31, v30, 11, s59
    v_cmp_eq_u32 vcc, 1, v25
    s_mul_i32 s59, s76, 544
    s_add_u32 s59, s59, 147456
    v_cndmask_b32 v36, v36, v31, vcc
    v_lshl_add_u32 v31, v25, 3, s59
    v_mul_u32_u24 v60, 272, v29
    v_add3_u32 v60, v60, v31, v26
    v_mul_u32_u24 v61, 272, v27
    v_add_u32 v61, v61, v31
    v_and_b32 v31, 3, v0
    v_bfe_u32 v27, v0, 2, 1
    buffer_load_dwordx4 v2, s[8:11], s6 offen offset:1024 lds
    v_lshl_add_u32 v31, v27, 3, v31
    v_bfe_u32 v27, v0, 3, 1
    v_lshl_add_u32 v31, v27, 2, v31
    v_cndmask_b32 v31, v31, 16, vcc
    v_lshlrev_b32 v31, 4, v31
    v_mul_u32_u24 v29, 544, v29
    s_mul_i32 s60, s5, 2176
    s_add_u32 s60, s60, 147456
    v_add3_u32 v62, v31, v29, s60
    s_lshr_b32 s65, s4, 1
    s_lshl1_add_u32 s65, s62, s65
    s_add_u32 m0, s56, 81920
    s_mul_i32 s6, s6, s78
    buffer_load_dwordx4 v3, s[12:15], s6 offen lds
    s_mul_i32 s79, s65, 236
    s_and_b32 s65, s4, 1
    s_add_u32 s79, s79, s65
    s_lshl2_add_u32 s59, s50, s79
    s_lshl_b32 s59, s59, 10
    s_add_u32 s68, s59, 1310720
    s_mov_b32 s52, 753664
    s_lshl3_add_u32 s51, s77, s52
    s_add_u32 s67, s68, 8192
    s_lshl1_add_u32 s59, s63, s5
    s_lshl2_add_u32 s59, s59, s79
    s_lshl_b32 s59, s59, 10
    s_add_u32 m0, s56, 82944
    s_nop 0
    buffer_load_dwordx4 v4, s[12:15], s6 offen lds
    s_add_u32 s66, s59, 1486848
    s_mov_b32 s30, 2097152
    s_mov_b32 s31, 0x00020000
    s_and_b32 s59, s74, 1
    s_lshl_b32 s59, s59, 1
    s_lshl3_add_u32 s59, s74, s3
    s_lshl_b32 s73, s59, 7
    s_add_u32 s73, s73, 4096
    s_lshl_b32 s59, s59, 6
    s_add_u32 s59, s59, s75
    s_lshl_b32 s69, s59, 7
    s_waitcnt lgkmcnt(0)
    s_waitcnt vmcnt(6)
    s_barrier
    ds_read_b128 v[128:131], v40 offset:0
    ds_read_b64_tr_b16 v[64:65], v20 offset:0
    ds_read_b64_tr_b16 v[66:67], v20 offset:512
    ds_read_b64_tr_b16 v[68:69], v20 offset:1024
    ds_read_b64_tr_b16 v[70:71], v20 offset:1536
    ds_read_b128 v[132:135], v41 offset:0
    ds_read_b64_tr_b16 v[72:73], v21 offset:0
    ds_read_b64_tr_b16 v[74:75], v21 offset:512
    ds_read_b64_tr_b16 v[76:77], v21 offset:1024
    ds_read_b64_tr_b16 v[78:79], v21 offset:1536
    s_waitcnt lgkmcnt(5)
    v_mfma_f32_32x32x16_bf16 v[96:111], v[64:67], v[128:131], 0
    ds_read_b128 v[136:139], v42 offset:0
    ds_read_b64_tr_b16 v[80:81], v22 offset:0
    ds_read_b64_tr_b16 v[82:83], v22 offset:512
    s_add_u32 m0, s56, 32768
    s_add_u32 s6, s61, 256
    s_and_b32 s6, s6, 0x380
    buffer_load_dwordx4 v1, s[8:11], s6 offen lds
    s_waitcnt vmcnt(5)
    v_add_u32 v243, 1, v250
    v_lshlrev_b32 v228, 16, v224
    v_and_b32 v229, 0xffff0000, v224
    v_lshlrev_b32 v230, 16, v225
    v_and_b32 v231, 0xffff0000, v225
    v_mfma_f32_32x32x16_bf16 v[112:127], v[68:71], v[128:131], 0
    ds_read_b64_tr_b16 v[84:85], v22 offset:1024
    ds_read_b64_tr_b16 v[86:87], v22 offset:1536
    buffer_load_dwordx4 v2, s[8:11], s6 offen offset:1024 lds
    v_mfma_f32_16x16x32_bf16 v[48:51], v[44:47], v[64:67], 0
    v_mfma_f32_16x16x32_bf16 v[52:55], v[44:47], v[68:71], 0
    v_lshlrev_b32 v232, 16, v226
    v_and_b32 v233, 0xffff0000, v226
    v_lshlrev_b32 v234, 16, v227
    v_and_b32 v235, 0xffff0000, v227
    s_waitcnt lgkmcnt(5)
    v_mfma_f32_32x32x16_bf16 v[96:111], v[72:75], v[132:135], v[96:111]
    ds_read_b128 v[140:143], v43 offset:0
    ds_read_b64_tr_b16 v[88:89], v23 offset:0
    ds_read_b64_tr_b16 v[90:91], v23 offset:512
    s_add_u32 m0, s56, 98304
    s_mul_i32 s6, s6, s78
    buffer_load_dwordx4 v3, s[12:15], s6 offen lds
    v_readfirstlane_b32 s57, v243
    v_add_f32 v224, v228, v229
    v_add_f32 v225, v230, v231
    v_add_f32 v226, v232, v233
    v_add_f32 v227, v234, v235
    v_mfma_f32_32x32x16_bf16 v[112:127], v[76:79], v[132:135], v[112:127]
    ds_read_b64_tr_b16 v[92:93], v23 offset:1024
    ds_read_b64_tr_b16 v[94:95], v23 offset:1536
    s_add_u32 m0, s56, 99328
    s_nop 0
    buffer_load_dwordx4 v4, s[12:15], s6 offen lds
    v_add_f32 v224, v224, v225
    v_add_f32 v226, v226, v227
    v_add_f32 v236, v224, v226
    s_nop 1
    v_add_f32_dpp v236, v236, v236 row_ror:8 row_mask:0xf bank_mask:0xf
    s_waitcnt vmcnt(4)
    s_barrier
    s_and_b32 s59, s2, 127
    v_lshlrev_b32 v24, 7, v0
    s_lshl3_add_u32 s59, s59, s3
    s_mul_i32 s59, s59, 1536
    s_mov_b64 exec, 0xfff
    v_add_u32 v24, s59, v24
    buffer_load_dword v251, v24, s[12:15], 0 offen
    s_mov_b64 exec, -1
    s_waitcnt lgkmcnt(5)
    v_mfma_f32_32x32x16_bf16 v[96:111], v[80:83], v[136:139], v[96:111]
    ds_read_b128 v[144:147], v40 offset:16384
    ds_read_b64_tr_b16 v[64:65], v20 offset:16384
    ds_read_b64_tr_b16 v[66:67], v20 offset:16896
    v_add_f32_dpp v236, v236, v236 row_ror:4 row_mask:0xf bank_mask:0xf
    s_nop 1
    v_add_f32_dpp v236, v236, v236 row_ror:2 row_mask:0xf bank_mask:0xf
    s_nop 1
    v_add_f32_dpp v236, v236, v236 row_ror:1 row_mask:0xf bank_mask:0xf
    v_mov_b32 v237, v236
    s_nop 1
    v_permlane16_swap_b32 v236, v237
    v_mfma_f32_32x32x16_bf16 v[112:127], v[84:87], v[136:139], v[112:127]
    ds_read_b64_tr_b16 v[68:69], v20 offset:17408
    ds_read_b64_tr_b16 v[70:71], v20 offset:17920
    s_add_u32 m0, s56, 49152
    s_add_u32 s6, s61, 384
    s_and_b32 s6, s6, 0x380
    buffer_load_dwordx4 v1, s[8:11], s6 offen lds
    v_add_f32 v236, v236, v237
    v_mov_b32 v237, v236
    s_nop 1
    v_permlane32_swap_b32 v236, v237
    v_add_f32 v236, v236, v237
    s_waitcnt lgkmcnt(5)
    v_mfma_f32_32x32x16_bf16 v[96:111], v[88:91], v[140:143], v[96:111]
    ds_read_b128 v[148:151], v41 offset:16384
    ds_read_b64_tr_b16 v[72:73], v21 offset:16384
    ds_read_b64_tr_b16 v[74:75], v21 offset:16896
    v_mul_f32 v240, 0xbb000000, v236
    v_add_f32 v228, v228, v240
    v_add_f32 v229, v229, v240
    v_add_f32 v230, v230, v240
    v_add_f32 v231, v231, v240
    v_mfma_f32_32x32x16_bf16 v[112:127], v[92:95], v[140:143], v[112:127]
    ds_read_b64_tr_b16 v[76:77], v21 offset:17408
    ds_read_b64_tr_b16 v[78:79], v21 offset:17920
    buffer_load_dwordx4 v2, s[8:11], s6 offen offset:1024 lds
    v_add_f32 v232, v232, v240
    v_add_f32 v233, v233, v240
    v_add_f32 v234, v234, v240
    v_add_f32 v235, v235, v240
    s_waitcnt lgkmcnt(5)
    v_mfma_f32_32x32x16_bf16 v[96:111], v[64:67], v[144:147], v[96:111]
    ds_read_b128 v[152:155], v42 offset:16384
    ds_read_b64_tr_b16 v[80:81], v22 offset:16384
    ds_read_b64_tr_b16 v[82:83], v22 offset:16896
    v_mul_f32 v224, v228, v228
    v_mul_f32 v225, v229, v229
    v_mul_f32 v226, v230, v230
    v_mul_f32 v227, v231, v231
    v_fmac_f32 v224, v232, v232
    v_mfma_f32_32x32x16_bf16 v[112:127], v[68:71], v[144:147], v[112:127]
    ds_read_b64_tr_b16 v[84:85], v22 offset:17408
    ds_read_b64_tr_b16 v[86:87], v22 offset:17920
    s_add_u32 m0, s56, 114688
    s_mul_i32 s6, s6, s78
    buffer_load_dwordx4 v3, s[12:15], s6 offen lds
    v_mfma_f32_16x16x32_bf16 v[48:51], v[44:47], v[64:67], v[48:51]
    v_mfma_f32_16x16x32_bf16 v[52:55], v[44:47], v[68:71], v[52:55]
    v_fmac_f32 v225, v233, v233
    v_fmac_f32 v226, v234, v234
    v_fmac_f32 v227, v235, v235
    v_add_f32 v224, v224, v225
    s_waitcnt lgkmcnt(5)
    v_mfma_f32_32x32x16_bf16 v[96:111], v[72:75], v[148:151], v[96:111]
    ds_read_b128 v[156:159], v43 offset:16384
    ds_read_b64_tr_b16 v[88:89], v23 offset:16384
    ds_read_b64_tr_b16 v[90:91], v23 offset:16896
    v_add_f32 v226, v226, v227
    v_add_f32 v236, v224, v226
    s_nop 1
    v_add_f32_dpp v236, v236, v236 row_ror:8 row_mask:0xf bank_mask:0xf
    s_nop 1
    v_add_f32_dpp v236, v236, v236 row_ror:4 row_mask:0xf bank_mask:0xf
    s_nop 1
    v_add_f32_dpp v236, v236, v236 row_ror:2 row_mask:0xf bank_mask:0xf
    v_mfma_f32_32x32x16_bf16 v[112:127], v[76:79], v[148:151], v[112:127]
    ds_read_b64_tr_b16 v[92:93], v23 offset:17408
    ds_read_b64_tr_b16 v[94:95], v23 offset:17920
    s_add_u32 m0, s56, 115712
    s_nop 0
    buffer_load_dwordx4 v4, s[12:15], s6 offen lds
    v_add_f32_dpp v236, v236, v236 row_ror:1 row_mask:0xf bank_mask:0xf
    v_mov_b32 v237, v236
    s_nop 1
    v_permlane16_swap_b32 v236, v237
    v_add_f32 v236, v236, v237
    s_waitcnt vmcnt(5)
    s_barrier
    s_mov_b32 exec_lo, 0xff
    s_mov_b32 exec_hi, 0x0
    buffer_load_dword v39, v252, s[20:23], 0 offen
    buffer_load_dword v39, v253, s[24:27], 0 offen
    s_mov_b64 exec, -1
    s_movk_i32 s42, 2752
    s_mov_b32 s43, 0x00020000
    s_lshl_b32 s65, s50, 6
    buffer_load_ushort v9, v8, s[40:43], s65 offen offset:128
    buffer_load_ushort v8, v8, s[40:43], s65 offen offset:0
    s_mov_b32 s38, 16384
    s_mov_b32 s39, 0x00020000
    s_and_b32 s59, s3, 1
    s_lshl_b32 s59, s59, 10
    s_lshl_b32 s60, s63, 11
    s_add_u32 s60, s60, s59
    s_add_u32 m0, s59, 149504
    s_mov_b32 s58, 200000
    buffer_load_dwordx4 v7, s[36:39], s60 offen lds
    buffer_load_dword v39, off, s[28:31], s69
    s_waitcnt lgkmcnt(5)
    v_mfma_f32_32x32x16_bf16 v[96:111], v[80:83], v[152:155], v[96:111]
    ds_read_b128 v[160:163], v40 offset:32768
    ds_read_b64_tr_b16 v[64:65], v20 offset:32768
    ds_read_b64_tr_b16 v[66:67], v20 offset:33280
    v_mov_b32 v237, v236
    s_nop 1
    v_permlane32_swap_b32 v236, v237
    v_add_f32 v236, v236, v237
    v_mov_b32 v237, 0x3727c5ac
    v_mfma_f32_32x32x16_bf16 v[112:127], v[84:87], v[152:155], v[112:127]
    ds_read_b64_tr_b16 v[68:69], v20 offset:33792
    ds_read_b64_tr_b16 v[70:71], v20 offset:34304
    s_add_u32 m0, s56, 0
    s_add_u32 s6, s61, 512
    s_and_b32 s6, s6, 0x380
    buffer_load_dwordx4 v1, s[8:11], s6 offen lds
    v_fmac_f32 v237, 0x3b000000, v236
    v_rsq_f32 v242, v237
    s_nop 0
    v_mul_f32 v241, v237, v242
    s_waitcnt lgkmcnt(5)
    v_mfma_f32_32x32x16_bf16 v[96:111], v[88:91], v[156:159], v[96:111]
    ds_read_b128 v[164:167], v41 offset:32768
    ds_read_b64_tr_b16 v[72:73], v21 offset:32768
    ds_read_b64_tr_b16 v[74:75], v21 offset:33280
    v_mfma_f32_32x32x16_bf16 v[112:127], v[92:95], v[156:159], v[112:127]
    ds_read_b64_tr_b16 v[76:77], v21 offset:33792
    ds_read_b64_tr_b16 v[78:79], v21 offset:34304
    buffer_load_dwordx4 v2, s[8:11], s6 offen offset:1024 lds
    s_mov_b64 exec, 1
    buffer_store_dwordx4 v[240:243], off, s[32:35], s77 sc1
    s_mov_b64 exec, -1
    s_waitcnt lgkmcnt(5)
    v_mfma_f32_32x32x16_bf16 v[96:111], v[64:67], v[160:163], v[96:111]
    ds_read_b128 v[168:171], v42 offset:32768
    ds_read_b64_tr_b16 v[80:81], v22 offset:32768
    ds_read_b64_tr_b16 v[82:83], v22 offset:33280
    v_mfma_f32_32x32x16_bf16 v[112:127], v[68:71], v[160:163], v[112:127]
    ds_read_b64_tr_b16 v[84:85], v22 offset:33792
    ds_read_b64_tr_b16 v[86:87], v22 offset:34304
    s_add_u32 m0, s56, 65536
    s_mul_i32 s6, s6, s78
    buffer_load_dwordx4 v3, s[12:15], s6 offen lds
    v_mfma_f32_16x16x32_bf16 v[48:51], v[44:47], v[64:67], v[48:51]
    v_mfma_f32_16x16x32_bf16 v[52:55], v[44:47], v[68:71], v[52:55]
    s_waitcnt lgkmcnt(5)
    v_mfma_f32_32x32x16_bf16 v[96:111], v[72:75], v[164:167], v[96:111]
    ds_read_b128 v[172:175], v43 offset:32768
    ds_read_b64_tr_b16 v[88:89], v23 offset:32768
    ds_read_b64_tr_b16 v[90:91], v23 offset:33280
    v_mfma_f32_32x32x16_bf16 v[112:127], v[76:79], v[164:167], v[112:127]
    ds_read_b64_tr_b16 v[92:93], v23 offset:33792
    ds_read_b64_tr_b16 v[94:95], v23 offset:34304
    s_add_u32 m0, s56, 66560
    s_nop 0
    buffer_load_dwordx4 v4, s[12:15], s6 offen lds
    s_waitcnt vmcnt(11)
    s_barrier
    s_waitcnt lgkmcnt(5)
    v_mfma_f32_32x32x16_bf16 v[96:111], v[80:83], v[168:171], v[96:111]
    ds_read_b128 v[176:179], v40 offset:49152
    ds_read_b64_tr_b16 v[64:65], v20 offset:49152
    ds_read_b64_tr_b16 v[66:67], v20 offset:49664
    v_mfma_f32_32x32x16_bf16 v[112:127], v[84:87], v[168:171], v[112:127]
    ds_read_b64_tr_b16 v[68:69], v20 offset:50176
    ds_read_b64_tr_b16 v[70:71], v20 offset:50688
    s_add_u32 m0, s56, 16384
    s_add_u32 s6, s61, 640
    s_and_b32 s6, s6, 0x380
    buffer_load_dwordx4 v1, s[8:11], s6 offen lds
    s_waitcnt lgkmcnt(5)
    v_mfma_f32_32x32x16_bf16 v[96:111], v[88:91], v[172:175], v[96:111]
    ds_read_b128 v[180:183], v41 offset:49152
    ds_read_b64_tr_b16 v[72:73], v21 offset:49152
    ds_read_b64_tr_b16 v[74:75], v21 offset:49664
    v_mfma_f32_32x32x16_bf16 v[112:127], v[92:95], v[172:175], v[112:127]
    ds_read_b64_tr_b16 v[76:77], v21 offset:50176
    ds_read_b64_tr_b16 v[78:79], v21 offset:50688
    buffer_load_dwordx4 v2, s[8:11], s6 offen offset:1024 lds
    s_waitcnt lgkmcnt(5)
    v_mfma_f32_32x32x16_bf16 v[96:111], v[64:67], v[176:179], v[96:111]
    ds_read_b128 v[184:187], v42 offset:49152
    ds_read_b64_tr_b16 v[80:81], v22 offset:49152
    ds_read_b64_tr_b16 v[82:83], v22 offset:49664
    v_mfma_f32_32x32x16_bf16 v[112:127], v[68:71], v[176:179], v[112:127]
    ds_read_b64_tr_b16 v[84:85], v22 offset:50176
    ds_read_b64_tr_b16 v[86:87], v22 offset:50688
    s_add_u32 m0, s56, 81920
    s_mul_i32 s6, s6, s78
    buffer_load_dwordx4 v3, s[12:15], s6 offen lds
    v_mfma_f32_16x16x32_bf16 v[48:51], v[44:47], v[64:67], v[48:51]
    v_mfma_f32_16x16x32_bf16 v[52:55], v[44:47], v[68:71], v[52:55]
    s_waitcnt lgkmcnt(5)
    v_mfma_f32_32x32x16_bf16 v[96:111], v[72:75], v[180:183], v[96:111]
    ds_read_b128 v[188:191], v43 offset:49152
    ds_read_b64_tr_b16 v[88:89], v23 offset:49152
    ds_read_b64_tr_b16 v[90:91], v23 offset:49664
    v_mfma_f32_32x32x16_bf16 v[112:127], v[76:79], v[180:183], v[112:127]
    ds_read_b64_tr_b16 v[92:93], v23 offset:50176
    ds_read_b64_tr_b16 v[94:95], v23 offset:50688
    s_add_u32 m0, s56, 82944
    s_nop 0
    buffer_load_dwordx4 v4, s[12:15], s6 offen lds
    s_waitcnt vmcnt(4)
    s_barrier
    s_waitcnt lgkmcnt(5)
    v_mfma_f32_32x32x16_bf16 v[96:111], v[80:83], v[184:187], v[96:111]
    ds_read_b128 v[192:195], v40 offset:0
    ds_read_b64_tr_b16 v[64:65], v20 offset:0
    ds_read_b64_tr_b16 v[66:67], v20 offset:512
    s_and_b32 s59, s74, 1
    v_mfma_f32_32x32x16_bf16 v[112:127], v[84:87], v[184:187], v[112:127]
    ds_read_b64_tr_b16 v[68:69], v20 offset:1024
    ds_read_b64_tr_b16 v[70:71], v20 offset:1536
    s_add_u32 m0, s56, 32768
    s_add_u32 s6, s61, 768
    s_and_b32 s6, s6, 0x380
    buffer_load_dwordx4 v1, s[8:11], s6 offen lds
    s_lshl_b32 s59, s59, 1
    s_waitcnt lgkmcnt(5)
    v_mfma_f32_32x32x16_bf16 v[96:111], v[88:91], v[188:191], v[96:111]
    ds_read_b128 v[196:199], v41 offset:0
    ds_read_b64_tr_b16 v[72:73], v21 offset:0
    ds_read_b64_tr_b16 v[74:75], v21 offset:512
    s_mov_b32 s36, -0.5
    v_mfma_f32_32x32x16_bf16 v[112:127], v[92:95], v[188:191], v[112:127]
    ds_read_b64_tr_b16 v[76:77], v21 offset:1024
    ds_read_b64_tr_b16 v[78:79], v21 offset:1536
    buffer_load_dwordx4 v2, s[8:11], s6 offen offset:1024 lds
    s_mov_b32 s37, -0.5
    s_waitcnt lgkmcnt(5)
    v_mfma_f32_32x32x16_bf16 v[96:111], v[64:67], v[192:195], v[96:111]
    ds_read_b128 v[200:203], v42 offset:0
    ds_read_b64_tr_b16 v[80:81], v22 offset:0
    ds_read_b64_tr_b16 v[82:83], v22 offset:512
    s_mov_b32 s38, 0x3f3504f3
    v_mfma_f32_32x32x16_bf16 v[112:127], v[68:71], v[192:195], v[112:127]
    ds_read_b64_tr_b16 v[84:85], v22 offset:1024
    ds_read_b64_tr_b16 v[86:87], v22 offset:1536
    s_add_u32 m0, s56, 98304
    s_mul_i32 s6, s6, s78
    buffer_load_dwordx4 v3, s[12:15], s6 offen lds
    v_mfma_f32_16x16x32_bf16 v[48:51], v[44:47], v[64:67], v[48:51]
    v_mfma_f32_16x16x32_bf16 v[52:55], v[44:47], v[68:71], v[52:55]
    s_mov_b32 s39, 0x3f3504f3
    s_waitcnt lgkmcnt(5)
    v_mfma_f32_32x32x16_bf16 v[96:111], v[72:75], v[196:199], v[96:111]
    ds_read_b128 v[204:207], v43 offset:0
    ds_read_b64_tr_b16 v[88:89], v23 offset:0
    ds_read_b64_tr_b16 v[90:91], v23 offset:512
    s_mov_b32 s40, -1
    v_mfma_f32_32x32x16_bf16 v[112:127], v[76:79], v[196:199], v[112:127]
    ds_read_b64_tr_b16 v[92:93], v23 offset:1024
    ds_read_b64_tr_b16 v[94:95], v23 offset:1536
    s_add_u32 m0, s56, 99328
    s_nop 0
    buffer_load_dwordx4 v4, s[12:15], s6 offen lds
    s_mov_b32 s41, 0
    s_waitcnt vmcnt(4)
    s_barrier
    s_waitcnt lgkmcnt(5)
    v_mfma_f32_32x32x16_bf16 v[96:111], v[80:83], v[200:203], v[96:111]
    ds_read_b128 v[208:211], v40 offset:16384
    ds_read_b64_tr_b16 v[64:65], v20 offset:16384
    ds_read_b64_tr_b16 v[66:67], v20 offset:16896
    s_mov_b32 s44, 0xffff0000
    v_mfma_f32_32x32x16_bf16 v[112:127], v[84:87], v[200:203], v[112:127]
    ds_read_b64_tr_b16 v[68:69], v20 offset:17408
    ds_read_b64_tr_b16 v[70:71], v20 offset:17920
    s_add_u32 m0, s56, 49152
    s_add_u32 s6, s61, 896
    s_and_b32 s6, s6, 0x380
    buffer_load_dwordx4 v1, s[8:11], s6 offen lds
    s_mov_b32 s45, 0
    s_waitcnt lgkmcnt(5)
    v_mfma_f32_32x32x16_bf16 v[96:111], v[88:91], v[204:207], v[96:111]
    ds_read_b128 v[212:215], v41 offset:16384
    ds_read_b64_tr_b16 v[72:73], v21 offset:16384
    ds_read_b64_tr_b16 v[74:75], v21 offset:16896
    s_lshl_b32 s42, 0x3333, s59
    v_mfma_f32_32x32x16_bf16 v[112:127], v[92:95], v[204:207], v[112:127]
    ds_read_b64_tr_b16 v[76:77], v21 offset:17408
    ds_read_b64_tr_b16 v[78:79], v21 offset:17920
    buffer_load_dwordx4 v2, s[8:11], s6 offen offset:1024 lds
    s_mov_b32 s43, 0
    s_waitcnt lgkmcnt(5)
    v_mfma_f32_32x32x16_bf16 v[96:111], v[64:67], v[208:211], v[96:111]
    ds_read_b128 v[216:219], v42 offset:16384
    ds_read_b64_tr_b16 v[80:81], v22 offset:16384
    ds_read_b64_tr_b16 v[82:83], v22 offset:16896
    v_mfma_f32_32x32x16_bf16 v[112:127], v[68:71], v[208:211], v[112:127]
    ds_read_b64_tr_b16 v[84:85], v22 offset:17408
    ds_read_b64_tr_b16 v[86:87], v22 offset:17920
    s_add_u32 m0, s56, 114688
    s_mul_i32 s6, s6, s78
    buffer_load_dwordx4 v3, s[12:15], s6 offen lds
    v_mfma_f32_16x16x32_bf16 v[48:51], v[44:47], v[64:67], v[48:51]
    v_mfma_f32_16x16x32_bf16 v[52:55], v[44:47], v[68:71], v[52:55]
    s_waitcnt lgkmcnt(5)
    v_mfma_f32_32x32x16_bf16 v[96:111], v[72:75], v[212:215], v[96:111]
    ds_read_b128 v[220:223], v43 offset:16384
    ds_read_b64_tr_b16 v[88:89], v23 offset:16384
    ds_read_b64_tr_b16 v[90:91], v23 offset:16896
    v_mfma_f32_32x32x16_bf16 v[112:127], v[76:79], v[212:215], v[112:127]
    ds_read_b64_tr_b16 v[92:93], v23 offset:17408
    ds_read_b64_tr_b16 v[94:95], v23 offset:17920
    s_add_u32 m0, s56, 115712
    s_nop 0
    buffer_load_dwordx4 v4, s[12:15], s6 offen lds
    s_waitcnt vmcnt(4)
    s_barrier
    s_add_u32 m0, s56, 131072
    s_xor_b32 s6, s71, 114688
    buffer_load_dwordx4 v32, s[20:23], s6 offen lds
    buffer_load_dwordx4 v33, s[20:23], s6 offen offset:1024 lds
    s_waitcnt lgkmcnt(5)
    v_mfma_f32_32x32x16_bf16 v[96:111], v[80:83], v[216:219], v[96:111]
    ds_read_b128 v[224:227], v40 offset:32768
    ds_read_b64_tr_b16 v[64:65], v20 offset:32768
    ds_read_b64_tr_b16 v[66:67], v20 offset:33280
    v_mfma_f32_32x32x16_bf16 v[112:127], v[84:87], v[216:219], v[112:127]
    ds_read_b64_tr_b16 v[68:69], v20 offset:33792
    ds_read_b64_tr_b16 v[70:71], v20 offset:34304
    s_add_u32 m0, s56, 0
    s_add_u32 s6, s61, 0
    s_and_b32 s6, s6, 0x380
    s_mul_i32 s6, s6, 1536
    buffer_load_dwordx4 v5, s[16:19], s6 offen lds
    s_waitcnt lgkmcnt(5)
    v_mfma_f32_32x32x16_bf16 v[96:111], v[88:91], v[220:223], v[96:111]
    ds_read_b128 v[228:231], v41 offset:32768
    ds_read_b64_tr_b16 v[72:73], v21 offset:32768
    ds_read_b64_tr_b16 v[74:75], v21 offset:33280
    v_mfma_f32_32x32x16_bf16 v[112:127], v[92:95], v[220:223], v[112:127]
    ds_read_b64_tr_b16 v[76:77], v21 offset:33792
    ds_read_b64_tr_b16 v[78:79], v21 offset:34304
    s_add_u32 m0, s56, 1024
    s_add_u32 s6, s61, 128
    s_and_b32 s6, s6, 0x380
    s_mul_i32 s6, s6, 1536
    buffer_load_dwordx4 v5, s[16:19], s6 offen lds
    s_waitcnt lgkmcnt(5)
    v_mfma_f32_32x32x16_bf16 v[96:111], v[64:67], v[224:227], v[96:111]
    ds_read_b128 v[232:235], v42 offset:32768
    ds_read_b64_tr_b16 v[80:81], v22 offset:32768
    ds_read_b64_tr_b16 v[82:83], v22 offset:33280
    v_mfma_f32_32x32x16_bf16 v[112:127], v[68:71], v[224:227], v[112:127]
    ds_read_b64_tr_b16 v[84:85], v22 offset:33792
    ds_read_b64_tr_b16 v[86:87], v22 offset:34304
    s_add_u32 m0, s56, 65536
    s_add_u32 s6, s61, 256
    s_and_b32 s6, s6, 0x380
    s_mul_i32 s6, s6, 1536
    buffer_load_dwordx4 v5, s[16:19], s6 offen lds
    v_mfma_f32_16x16x32_bf16 v[48:51], v[44:47], v[64:67], v[48:51]
    v_mfma_f32_16x16x32_bf16 v[52:55], v[44:47], v[68:71], v[52:55]
    buffer_load_dwordx4 v[10:13], v6, s[32:35], 0 offen sc1
    s_waitcnt lgkmcnt(5)
    v_mfma_f32_32x32x16_bf16 v[96:111], v[72:75], v[228:231], v[96:111]
    ds_read_b128 v[236:239], v43 offset:32768
    ds_read_b64_tr_b16 v[88:89], v23 offset:32768
    ds_read_b64_tr_b16 v[90:91], v23 offset:33280
    v_mfma_f32_32x32x16_bf16 v[112:127], v[76:79], v[228:231], v[112:127]
    ds_read_b64_tr_b16 v[92:93], v23 offset:33792
    ds_read_b64_tr_b16 v[94:95], v23 offset:34304
    s_add_u32 m0, s56, 66560
    s_add_u32 s6, s61, 384
    s_and_b32 s6, s6, 0x380
    s_mul_i32 s6, s6, 1536
    buffer_load_dwordx4 v5, s[16:19], s6 offen lds
    s_waitcnt vmcnt(7)
    s_barrier
    s_waitcnt lgkmcnt(5)
    v_mfma_f32_32x32x16_bf16 v[96:111], v[80:83], v[232:235], v[96:111]
    ds_read_b128 v[240:243], v40 offset:49152
    ds_read_b64_tr_b16 v[64:65], v20 offset:49152
    ds_read_b64_tr_b16 v[66:67], v20 offset:49664
    v_mfma_f32_32x32x16_bf16 v[112:127], v[84:87], v[232:235], v[112:127]
    ds_read_b64_tr_b16 v[68:69], v20 offset:50176
    ds_read_b64_tr_b16 v[70:71], v20 offset:50688
    s_add_u32 m0, s56, 16384
    s_add_u32 s6, s61, 512
    s_and_b32 s6, s6, 0x380
    s_mul_i32 s6, s6, 1536
    buffer_load_dwordx4 v5, s[16:19], s6 offen lds
    s_waitcnt lgkmcnt(5)
    v_mfma_f32_32x32x16_bf16 v[96:111], v[88:91], v[236:239], v[96:111]
    ds_read_b128 v[244:247], v41 offset:49152
    ds_read_b64_tr_b16 v[72:73], v21 offset:49152
    ds_read_b64_tr_b16 v[74:75], v21 offset:49664
    v_mov_b32 v24, -1
    v_mfma_f32_32x32x16_bf16 v[112:127], v[92:95], v[236:239], v[112:127]
    ds_read_b64_tr_b16 v[76:77], v21 offset:50176
    ds_read_b64_tr_b16 v[78:79], v21 offset:50688
    s_add_u32 m0, s56, 17408
    s_add_u32 s6, s61, 640
    s_and_b32 s6, s6, 0x380
    s_mul_i32 s6, s6, 1536
    buffer_load_dwordx4 v5, s[16:19], s6 offen lds
    s_waitcnt lgkmcnt(5)
    v_mfma_f32_32x32x16_bf16 v[96:111], v[64:67], v[240:243], v[96:111]
    ds_read_b128 v[248:251], v42 offset:49152
    ds_read_b64_tr_b16 v[80:81], v22 offset:49152
    ds_read_b64_tr_b16 v[82:83], v22 offset:49664
    buffer_store_dwordx4 v[24:27], v7, s[32:35], s66 offen offset:0 sc1
    v_mfma_f32_32x32x16_bf16 v[112:127], v[68:71], v[240:243], v[112:127]
    ds_read_b64_tr_b16 v[84:85], v22 offset:50176
    ds_read_b64_tr_b16 v[86:87], v22 offset:50688
    s_add_u32 m0, s56, 81920
    s_add_u32 s6, s61, 768
    s_and_b32 s6, s6, 0x380
    s_mul_i32 s6, s6, 1536
    buffer_load_dwordx4 v5, s[16:19], s6 offen lds
    v_mfma_f32_16x16x32_bf16 v[48:51], v[44:47], v[64:67], v[48:51]
    v_mfma_f32_16x16x32_bf16 v[52:55], v[44:47], v[68:71], v[52:55]
    buffer_store_dwordx4 v[24:27], v7, s[32:35], s66 offen offset:2048 sc1
    s_waitcnt lgkmcnt(5)
    v_mfma_f32_32x32x16_bf16 v[96:111], v[72:75], v[244:247], v[96:111]
    ds_read_b128 v[252:255], v43 offset:49152
    ds_read_b64_tr_b16 v[88:89], v23 offset:49152
    ds_read_b64_tr_b16 v[90:91], v23 offset:49664
    s_nop 0
    ds_write_b32 v14, v48 offset:0
    ds_write_b32 v14, v52 offset:1024
    v_mfma_f32_32x32x16_bf16 v[112:127], v[76:79], v[244:247], v[112:127]
    ds_read_b64_tr_b16 v[92:93], v23 offset:50176
    ds_read_b64_tr_b16 v[94:95], v23 offset:50688
    s_add_u32 m0, s56, 82944
    s_add_u32 s6, s61, 896
    s_and_b32 s6, s6, 0x380
    s_mul_i32 s6, s6, 1536
    buffer_load_dwordx4 v5, s[16:19], s6 offen lds
    s_waitcnt vmcnt(7)
L_rec1_17_c:
    v_cmp_ne_u32 vcc, s57, v13
    s_cbranch_vccnz L_rec1_17_r
L_rec1_17_k:
    s_nop 0
    v_cndmask_b32 v10, v11, v10, s[40:41]
    v_mov_b32 v13, v12
    v_mul_f32 v12, 0x3fb8aa3b, v12
    s_waitcnt vmcnt(6)
    s_waitcnt lgkmcnt(0)
    s_barrier
    s_mov_b64 exec, s[44:45]
    buffer_load_dword v39, v36, s[32:35], 0 offen offset:12 sc1
    s_mov_b64 exec, -1
    v_mfma_f32_32x32x16_bf16 v[96:111], v[80:83], v[248:251], v[96:111]
    ds_read_b64_tr_b16 v[64:65], v16 offset:0
    ds_read_b64_tr_b16 v[66:67], v16 offset:512
    ds_read_b64_tr_b16 v[68:69], v17 offset:0
    ds_read_b128 v[24:27], v15 offset:0
    ds_read_b128 v[28:31], v15 offset:1024
    v_mov_b32 v1, v38
    v_xor_b32 v2, 64, v38
    v_mfma_f32_32x32x16_bf16 v[112:127], v[84:87], v[248:251], v[112:127]
    ds_read_b64_tr_b16 v[70:71], v17 offset:512
    v_add_u32 v3, 65536, v1
    v_add_u32 v4, 65536, v2
    v_add_u32 v5, 131072, v1
    v_add_u32 v6, 131072, v2
    v_mov_b32 v38, -1
    v_mfma_f32_32x32x16_bf16 v[96:111], v[88:91], v[252:255], v[96:111]
    ds_read_b64_tr_b16 v[72:73], v18 offset:0
    ds_read_b64_tr_b16 v[74:75], v18 offset:512
    s_add_u32 m0, s56, 32768
    s_mov_b32 s6, 131072
    buffer_load_dwordx4 v32, s[20:23], s6 offen lds
    buffer_load_dwordx4 v33, s[20:23], s6 offen offset:1024 lds
    v_lshlrev_b32 v8, 16, v8
    v_mfma_f32_32x32x16_bf16 v[112:127], v[92:95], v[252:255], v[112:127]
    v_lshlrev_b32 v9, 16, v9
    s_waitcnt lgkmcnt(3)
    v_add_f32 v24, v24, v25
    v_add_f32 v26, v26, v27
    v_add_f32 v28, v28, v29
    v_add_f32 v30, v30, v31
    v_add_f32 v24, v24, v26
    v_add_f32 v28, v28, v30
    v_cndmask_b32 v24, v8, v24, s[40:41]
    v_cndmask_b32 v28, v9, v28, s[40:41]
    v_mfma_f32_16x16x32_bf16 v[48:51], v[44:47], v[64:67], 0
    v_mfma_f32_32x32x16_bf16 v[80:95], v[64:67], v[128:131], 0
    ds_read_b64_tr_b16 v[76:77], v19 offset:0
    ds_read_b64_tr_b16 v[78:79], v19 offset:512
    v_mfma_f32_32x32x2_f32 v[96:111], v24, v10, v[96:111]
    v_mfma_f32_32x32x2_f32 v[112:127], v28, v10, v[112:127]
    s_waitcnt lgkmcnt(4)
    v_mfma_f32_32x32x16_bf16 v[80:95], v[68:71], v[132:135], v[80:95]
    ds_read_b64_tr_b16 v[64:65], v16 offset:1024
    ds_read_b64_tr_b16 v[66:67], v16 offset:1536
    s_nop 12
    v_pk_fma_f32 v[24:25], v[96:97], v[12:13], s[36:37] op_sel_hi:[1,0,1]
    v_pk_fma_f32 v[26:27], v[98:99], v[12:13], s[36:37] op_sel_hi:[1,0,1]
    v_pk_fma_f32 v[28:29], v[100:101], v[12:13], s[36:37] op_sel_hi:[1,0,1]
    v_pk_fma_f32 v[30:31], v[102:103], v[12:13], s[36:37] op_sel_hi:[1,0,1]
    v_exp_f32 v24, v24
    v_exp_f32 v25, v25
    v_exp_f32 v26, v26
    v_exp_f32 v27, v27
    v_exp_f32 v28, v28
    v_exp_f32 v29, v29
    v_exp_f32 v30, v30
    v_exp_f32 v31, v31
    v_pk_add_f32 v[24:25], v[24:25], s[38:39]
    v_pk_add_f32 v[26:27], v[26:27], s[38:39]
    v_pk_add_f32 v[28:29], v[28:29], s[38:39]
    v_pk_add_f32 v[30:31], v[30:31], s[38:39]
    v_pk_fma_f32 v[24:25], v[24:25], v[24:25], s[36:37] neg_lo:[1,0,0] neg_hi:[1,0,0]
    v_pk_fma_f32 v[26:27], v[26:27], v[26:27], s[36:37] neg_lo:[1,0,0] neg_hi:[1,0,0]
    v_pk_fma_f32 v[28:29], v[28:29], v[28:29], s[36:37] neg_lo:[1,0,0] neg_hi:[1,0,0]
    v_pk_fma_f32 v[30:31], v[30:31], v[30:31], s[36:37] neg_lo:[1,0,0] neg_hi:[1,0,0]
    s_add_u32 m0, s56, 49152
    s_mov_b32 s6, 147456
    buffer_load_dwordx4 v32, s[20:23], s6 offen lds
    buffer_load_dwordx4 v33, s[20:23], s6 offen offset:1024 lds
    v_rcp_f32 v24, v24
    v_rcp_f32 v25, v25
    v_rcp_f32 v26, v26
    v_rcp_f32 v27, v27
    v_rcp_f32 v28, v28
    v_rcp_f32 v29, v29
    v_rcp_f32 v30, v30
    v_rcp_f32 v31, v31
    v_pk_fma_f32 v[96:97], v[96:97], v[24:25], v[96:97]
    v_pk_fma_f32 v[98:99], v[98:99], v[26:27], v[98:99]
    v_pk_fma_f32 v[100:101], v[100:101], v[28:29], v[100:101]
    v_pk_fma_f32 v[102:103], v[102:103], v[30:31], v[102:103]
    v_cvt_pk_bf16_f32 v96, v96, v97
    v_cvt_pk_bf16_f32 v97, v98, v99
    v_cvt_pk_bf16_f32 v98, v100, v101
    v_cvt_pk_bf16_f32 v99, v102, v103
    buffer_store_dwordx4 v[96:99], v7, s[32:35], s68 offen offset:0 sc1
    v_pk_fma_f32 v[24:25], v[104:105], v[12:13], s[36:37] op_sel_hi:[1,0,1]
    v_pk_fma_f32 v[26:27], v[106:107], v[12:13], s[36:37] op_sel_hi:[1,0,1]
    v_pk_fma_f32 v[28:29], v[108:109], v[12:13], s[36:37] op_sel_hi:[1,0,1]
    v_pk_fma_f32 v[30:31], v[110:111], v[12:13], s[36:37] op_sel_hi:[1,0,1]
    v_exp_f32 v24, v24
    v_exp_f32 v25, v25
    v_exp_f32 v26, v26
    v_exp_f32 v27, v27
    v_exp_f32 v28, v28
    v_exp_f32 v29, v29
    v_exp_f32 v30, v30
    v_exp_f32 v31, v31
    v_pk_add_f32 v[24:25], v[24:25], s[38:39]
    v_pk_add_f32 v[26:27], v[26:27], s[38:39]
    v_pk_add_f32 v[28:29], v[28:29], s[38:39]
    v_pk_add_f32 v[30:31], v[30:31], s[38:39]
    v_pk_fma_f32 v[24:25], v[24:25], v[24:25], s[36:37] neg_lo:[1,0,0] neg_hi:[1,0,0]
    v_pk_fma_f32 v[26:27], v[26:27], v[26:27], s[36:37] neg_lo:[1,0,0] neg_hi:[1,0,0]
    s_waitcnt lgkmcnt(4)
    v_mfma_f32_32x32x16_bf16 v[80:95], v[72:75], v[136:139], v[80:95]
    ds_read_b64_tr_b16 v[68:69], v17 offset:1024
    ds_read_b64_tr_b16 v[70:71], v17 offset:1536
    v_pk_fma_f32 v[28:29], v[28:29], v[28:29], s[36:37] neg_lo:[1,0,0] neg_hi:[1,0,0]
    v_pk_fma_f32 v[30:31], v[30:31], v[30:31], s[36:37] neg_lo:[1,0,0] neg_hi:[1,0,0]
    v_rcp_f32 v24, v24
    v_rcp_f32 v25, v25
    v_rcp_f32 v26, v26
    v_rcp_f32 v27, v27
    v_rcp_f32 v28, v28
    v_rcp_f32 v29, v29
    v_rcp_f32 v30, v30
    v_rcp_f32 v31, v31
    s_add_u32 m0, s56, 98304
    s_xor_b32 s6, s54, 0
    buffer_load_dwordx4 v34, s[24:27], s6 offen lds
    buffer_load_dwordx4 v35, s[24:27], s6 offen offset:1024 lds
    v_pk_fma_f32 v[104:105], v[104:105], v[24:25], v[104:105]
    v_pk_fma_f32 v[106:107], v[106:107], v[26:27], v[106:107]
    v_pk_fma_f32 v[108:109], v[108:109], v[28:29], v[108:109]
    v_pk_fma_f32 v[110:111], v[110:111], v[30:31], v[110:111]
    v_cvt_pk_bf16_f32 v100, v104, v105
    v_cvt_pk_bf16_f32 v101, v106, v107
    v_cvt_pk_bf16_f32 v102, v108, v109
    v_cvt_pk_bf16_f32 v103, v110, v111
    buffer_store_dwordx4 v[100:103], v7, s[32:35], s68 offen offset:2048 sc1
    v_pk_fma_f32 v[24:25], v[112:113], v[12:13], s[36:37] op_sel_hi:[1,0,1]
    v_pk_fma_f32 v[26:27], v[114:115], v[12:13], s[36:37] op_sel_hi:[1,0,1]
    v_pk_fma_f32 v[28:29], v[116:117], v[12:13], s[36:37] op_sel_hi:[1,0,1]
    v_pk_fma_f32 v[30:31], v[118:119], v[12:13], s[36:37] op_sel_hi:[1,0,1]
    v_exp_f32 v24, v24
    v_exp_f32 v25, v25
    v_exp_f32 v26, v26
    v_exp_f32 v27, v27
    v_exp_f32 v28, v28
    v_exp_f32 v29, v29
    v_exp_f32 v30, v30
    v_exp_f32 v31, v31
    v_pk_add_f32 v[24:25], v[24:25], s[38:39]
    v_pk_add_f32 v[26:27], v[26:27], s[38:39]
    v_pk_add_f32 v[28:29], v[28:29], s[38:39]
    v_pk_add_f32 v[30:31], v[30:31], s[38:39]
    v_pk_fma_f32 v[24:25], v[24:25], v[24:25], s[36:37] neg_lo:[1,0,0] neg_hi:[1,0,0]
    v_pk_fma_f32 v[26:27], v[26:27], v[26:27], s[36:37] neg_lo:[1,0,0] neg_hi:[1,0,0]
    v_pk_fma_f32 v[28:29], v[28:29], v[28:29], s[36:37] neg_lo:[1,0,0] neg_hi:[1,0,0]
    v_pk_fma_f32 v[30:31], v[30:31], v[30:31], s[36:37] neg_lo:[1,0,0] neg_hi:[1,0,0]
    v_rcp_f32 v24, v24
    v_rcp_f32 v25, v25
    v_rcp_f32 v26, v26
    v_rcp_f32 v27, v27
    v_rcp_f32 v28, v28
    v_rcp_f32 v29, v29
    v_rcp_f32 v30, v30
    v_rcp_f32 v31, v31
    v_pk_fma_f32 v[112:113], v[112:113], v[24:25], v[112:113]
    v_pk_fma_f32 v[114:115], v[114:115], v[26:27], v[114:115]
    v_pk_fma_f32 v[116:117], v[116:117], v[28:29], v[116:117]
    v_pk_fma_f32 v[118:119], v[118:119], v[30:31], v[118:119]
    v_cvt_pk_bf16_f32 v112, v112, v113
    v_cvt_pk_bf16_f32 v113, v114, v115
    v_cvt_pk_bf16_f32 v114, v116, v117
    s_waitcnt lgkmcnt(4)
    v_mfma_f32_32x32x16_bf16 v[80:95], v[76:79], v[140:143], v[80:95]
    ds_read_b64_tr_b16 v[72:73], v18 offset:1024
    ds_read_b64_tr_b16 v[74:75], v18 offset:1536
    v_cvt_pk_bf16_f32 v115, v118, v119
    buffer_store_dwordx4 v[112:115], v7, s[32:35], s67 offen offset:0 sc1
    v_pk_fma_f32 v[24:25], v[120:121], v[12:13], s[36:37] op_sel_hi:[1,0,1]
    v_pk_fma_f32 v[26:27], v[122:123], v[12:13], s[36:37] op_sel_hi:[1,0,1]
    v_pk_fma_f32 v[28:29], v[124:125], v[12:13], s[36:37] op_sel_hi:[1,0,1]
    v_pk_fma_f32 v[30:31], v[126:127], v[12:13], s[36:37] op_sel_hi:[1,0,1]
    v_exp_f32 v24, v24
    s_add_u32 m0, s56, 114688
    s_xor_b32 s6, s54, 16384
    buffer_load_dwordx4 v34, s[24:27], s6 offen lds
    buffer_load_dwordx4 v35, s[24:27], s6 offen offset:1024 lds
    v_exp_f32 v25, v25
    v_exp_f32 v26, v26
    v_exp_f32 v27, v27
    v_exp_f32 v28, v28
    v_exp_f32 v29, v29
    v_exp_f32 v30, v30
    v_exp_f32 v31, v31
    v_pk_add_f32 v[24:25], v[24:25], s[38:39]
    v_pk_add_f32 v[26:27], v[26:27], s[38:39]
    v_pk_add_f32 v[28:29], v[28:29], s[38:39]
    v_pk_add_f32 v[30:31], v[30:31], s[38:39]
    v_pk_fma_f32 v[24:25], v[24:25], v[24:25], s[36:37] neg_lo:[1,0,0] neg_hi:[1,0,0]
    v_pk_fma_f32 v[26:27], v[26:27], v[26:27], s[36:37] neg_lo:[1,0,0] neg_hi:[1,0,0]
    v_pk_fma_f32 v[28:29], v[28:29], v[28:29], s[36:37] neg_lo:[1,0,0] neg_hi:[1,0,0]
    v_pk_fma_f32 v[30:31], v[30:31], v[30:31], s[36:37] neg_lo:[1,0,0] neg_hi:[1,0,0]
    v_rcp_f32 v24, v24
    v_rcp_f32 v25, v25
    v_rcp_f32 v26, v26
    v_rcp_f32 v27, v27
    v_rcp_f32 v28, v28
    v_rcp_f32 v29, v29
    v_rcp_f32 v30, v30
    v_rcp_f32 v31, v31
    v_pk_fma_f32 v[120:121], v[120:121], v[24:25], v[120:121]
    v_pk_fma_f32 v[122:123], v[122:123], v[26:27], v[122:123]
    v_pk_fma_f32 v[124:125], v[124:125], v[28:29], v[124:125]
    v_pk_fma_f32 v[126:127], v[126:127], v[30:31], v[126:127]
    v_cvt_pk_bf16_f32 v116, v120, v121
    v_cvt_pk_bf16_f32 v117, v122, v123
    v_cvt_pk_bf16_f32 v118, v124, v125
    v_cvt_pk_bf16_f32 v119, v126, v127
    buffer_store_dwordx4 v[116:119], v7, s[32:35], s67 offen offset:2048 sc1
    v_and_b32 v104, 1, v0
    v_mov_b32 v105, 0x3f80
    v_lshlrev_b32 v104, 4, v104
    v_lshlrev_b32 v105, v104, v105
    v_bfe_u32 v104, v0, 1, 3
    v_cmp_eq_u32 vcc, 0, v104
    v_cmp_eq_u32 s[46:47], 1, v104
    s_nop 0
    v_cndmask_b32 v24, 0, v105, vcc
    v_cndmask_b32 v25, 0, v105, s[46:47]
    v_cmp_eq_u32 vcc, 2, v104
    v_cmp_eq_u32 s[46:47], 3, v104
    s_nop 0
    v_cndmask_b32 v26, 0, v105, vcc
    v_cndmask_b32 v27, 0, v105, s[46:47]
    v_cmp_eq_u32 vcc, 4, v104
    v_cmp_eq_u32 s[46:47], 5, v104
    s_nop 0
    v_cndmask_b32 v28, 0, v105, vcc
    v_cndmask_b32 v29, 0, v105, s[46:47]
    v_cmp_eq_u32 vcc, 6, v104
    v_cmp_eq_u32 s[46:47], 7, v104
    s_nop 0
    v_cndmask_b32 v30, 0, v105, vcc
    v_cndmask_b32 v31, 0, v105, s[46:47]
    s_waitcnt lgkmcnt(4)
    v_mfma_f32_16x16x32_bf16 v[48:51], v[44:47], v[64:67], v[48:51]
    v_mfma_f32_32x32x16_bf16 v[80:95], v[64:67], v[144:147], v[80:95]
    ds_read_b64_tr_b16 v[76:77], v19 offset:1024
    ds_read_b64_tr_b16 v[78:79], v19 offset:1536
    s_waitcnt lgkmcnt(4)
    v_mfma_f32_32x32x16_bf16 v[80:95], v[68:71], v[148:151], v[80:95]
    ds_read_b64_tr_b16 v[64:65], v20 offset:0
    ds_read_b64_tr_b16 v[66:67], v20 offset:512
    s_xor_b32 s6, s71, 0
    buffer_load_dwordx4 v[132:135], v32, s[20:23], s6 offen
    s_waitcnt lgkmcnt(4)
    v_mfma_f32_32x32x16_bf16 v[80:95], v[72:75], v[152:155], v[80:95]
    ds_read_b64_tr_b16 v[68:69], v21 offset:0
    ds_read_b64_tr_b16 v[70:71], v21 offset:512
    s_xor_b32 s6, s71, 0
    buffer_load_dwordx4 v[136:139], v33, s[20:23], s6 offen offset:1024
    s_waitcnt lgkmcnt(4)
    v_mfma_f32_32x32x16_bf16 v[80:95], v[76:79], v[156:159], v[80:95]
    ds_read_b64_tr_b16 v[72:73], v22 offset:0
    ds_read_b64_tr_b16 v[74:75], v22 offset:512
    s_waitcnt lgkmcnt(4)
    v_mfma_f32_16x16x32_bf16 v[48:51], v[44:47], v[64:67], v[48:51]
    v_mfma_f32_32x32x16_bf16 v[80:95], v[64:67], v[160:163], v[80:95]
    ds_read_b64_tr_b16 v[76:77], v23 offset:0
    ds_read_b64_tr_b16 v[78:79], v23 offset:512
    s_xor_b32 s6, s71, 16384
    buffer_load_dwordx4 v[140:143], v32, s[20:23], s6 offen
    s_waitcnt lgkmcnt(4)
    v_mfma_f32_32x32x16_bf16 v[80:95], v[68:71], v[164:167], v[80:95]
    ds_read_b64_tr_b16 v[64:65], v20 offset:1024
    ds_read_b64_tr_b16 v[66:67], v20 offset:1536
    s_xor_b32 s6, s71, 16384
    buffer_load_dwordx4 v[144:147], v33, s[20:23], s6 offen offset:1024
    s_waitcnt lgkmcnt(4)
    v_mfma_f32_32x32x16_bf16 v[80:95], v[72:75], v[168:171], v[80:95]
    ds_read_b64_tr_b16 v[68:69], v21 offset:1024
    ds_read_b64_tr_b16 v[70:71], v21 offset:1536
    s_waitcnt lgkmcnt(4)
    v_mfma_f32_32x32x16_bf16 v[80:95], v[76:79], v[172:175], v[80:95]
    ds_read_b64_tr_b16 v[72:73], v22 offset:1024
    ds_read_b64_tr_b16 v[74:75], v22 offset:1536
    s_xor_b32 s6, s71, 32768
    buffer_load_dwordx4 v[148:151], v32, s[20:23], s6 offen
    s_waitcnt lgkmcnt(4)
    v_mfma_f32_16x16x32_bf16 v[48:51], v[44:47], v[64:67], v[48:51]
    v_mfma_f32_32x32x16_bf16 v[80:95], v[64:67], v[176:179], v[80:95]
    ds_read_b64_tr_b16 v[76:77], v23 offset:1024
    ds_read_b64_tr_b16 v[78:79], v23 offset:1536
    s_xor_b32 s6, s71, 32768
    buffer_load_dwordx4 v[152:155], v33, s[20:23], s6 offen offset:1024
    s_waitcnt vmcnt(18)
L_fl_18_c:
    v_cmp_ne_u32 vcc, s57, v39
    s_and_b64 vcc, vcc, s[44:45]
    s_cbranch_vccnz L_fl_18_r
L_fl_18_k:
    s_waitcnt lgkmcnt(0)
    s_barrier
    v_lshlrev_b32 v36, 3, v36
    v_mfma_f32_32x32x16_bf16 v[80:95], v[68:71], v[180:183], v[80:95]
    ds_read_b64_tr_b16 v[64:65], v16 offset:16384
    ds_read_b64_tr_b16 v[66:67], v16 offset:16896
    v_mfma_f32_32x32x16_bf16 v[80:95], v[72:75], v[184:187], v[80:95]
    ds_read_b64_tr_b16 v[68:69], v17 offset:16384
    ds_read_b64_tr_b16 v[70:71], v17 offset:16896
    s_xor_b32 s6, s71, 49152
    buffer_load_dwordx4 v[156:159], v32, s[20:23], s6 offen
    v_mfma_f32_32x32x16_bf16 v[80:95], v[76:79], v[188:191], v[80:95]
    ds_read_b64_tr_b16 v[72:73], v18 offset:16384
    ds_read_b64_tr_b16 v[74:75], v18 offset:16896
    s_xor_b32 s6, s71, 49152
    buffer_load_dwordx4 v[160:163], v33, s[20:23], s6 offen offset:1024
    s_waitcnt lgkmcnt(4)
    v_mfma_f32_16x16x32_bf16 v[48:51], v[44:47], v[64:67], v[48:51]
    v_mfma_f32_32x32x16_bf16 v[80:95], v[64:67], v[192:195], v[80:95]
    ds_read_b64_tr_b16 v[76:77], v19 offset:16384
    ds_read_b64_tr_b16 v[78:79], v19 offset:16896
    s_waitcnt lgkmcnt(4)
    v_mfma_f32_32x32x16_bf16 v[80:95], v[68:71], v[196:199], v[80:95]
    ds_read_b64_tr_b16 v[64:65], v16 offset:17408
    ds_read_b64_tr_b16 v[66:67], v16 offset:17920
    s_xor_b32 s6, s71, 65536
    buffer_load_dwordx4 v[164:167], v32, s[20:23], s6 offen
    s_waitcnt lgkmcnt(4)
    v_mfma_f32_32x32x16_bf16 v[80:95], v[72:75], v[200:203], v[80:95]
    ds_read_b64_tr_b16 v[68:69], v17 offset:17408
    ds_read_b64_tr_b16 v[70:71], v17 offset:17920
    s_xor_b32 s6, s71, 65536
    buffer_load_dwordx4 v[168:171], v33, s[20:23], s6 offen offset:1024
    s_waitcnt lgkmcnt(4)
    v_mfma_f32_32x32x16_bf16 v[80:95], v[76:79], v[204:207], v[80:95]
    ds_read_b64_tr_b16 v[72:73], v18 offset:17408
    ds_read_b64_tr_b16 v[74:75], v18 offset:17920
    s_waitcnt lgkmcnt(4)
    v_mfma_f32_16x16x32_bf16 v[48:51], v[44:47], v[64:67], v[48:51]
    v_mfma_f32_32x32x16_bf16 v[80:95], v[64:67], v[208:211], v[80:95]
    ds_read_b64_tr_b16 v[76:77], v19 offset:17408
    ds_read_b64_tr_b16 v[78:79], v19 offset:17920
    s_xor_b32 s6, s71, 81920
    buffer_load_dwordx4 v[172:175], v32, s[20:23], s6 offen
    s_waitcnt lgkmcnt(4)
    v_mfma_f32_32x32x16_bf16 v[80:95], v[68:71], v[212:215], v[80:95]
    ds_read_b64_tr_b16 v[64:65], v20 offset:16384
    ds_read_b64_tr_b16 v[66:67], v20 offset:16896
    s_xor_b32 s6, s71, 81920
    buffer_load_dwordx4 v[176:179], v33, s[20:23], s6 offen offset:1024
    s_waitcnt lgkmcnt(4)
    v_mfma_f32_32x32x16_bf16 v[80:95], v[72:75], v[216:219], v[80:95]
    ds_read_b64_tr_b16 v[68:69], v21 offset:16384
    ds_read_b64_tr_b16 v[70:71], v21 offset:16896
    s_waitcnt lgkmcnt(4)
    v_mfma_f32_32x32x16_bf16 v[80:95], v[76:79], v[220:223], v[80:95]
    ds_read_b64_tr_b16 v[72:73], v22 offset:16384
    ds_read_b64_tr_b16 v[74:75], v22 offset:16896
    s_xor_b32 s6, s71, 98304
    buffer_load_dwordx4 v[180:183], v32, s[20:23], s6 offen
    s_waitcnt lgkmcnt(4)
    v_mfma_f32_16x16x32_bf16 v[48:51], v[44:47], v[64:67], v[48:51]
    v_mfma_f32_32x32x16_bf16 v[80:95], v[64:67], v[224:227], v[80:95]
    ds_read_b64_tr_b16 v[76:77], v23 offset:16384
    ds_read_b64_tr_b16 v[78:79], v23 offset:16896
    s_xor_b32 s6, s71, 98304
    buffer_load_dwordx4 v[184:187], v33, s[20:23], s6 offen offset:1024
    ds_read_b64_tr_b16 v[40:41], v56 offset:0
    ds_read_b64_tr_b16 v[42:43], v56 offset:256
    ds_read_b64_tr_b16 v[52:53], v56 offset:512
    ds_read_b64_tr_b16 v[54:55], v56 offset:768
    s_waitcnt lgkmcnt(8)
    v_mfma_f32_32x32x16_bf16 v[80:95], v[68:71], v[228:231], v[80:95]
    ds_read_b64_tr_b16 v[64:65], v20 offset:17408
    ds_read_b64_tr_b16 v[66:67], v20 offset:17920
    s_waitcnt lgkmcnt(8)
    v_mfma_f32_32x32x16_bf16 v[80:95], v[72:75], v[232:235], v[80:95]
    ds_read_b64_tr_b16 v[68:69], v21 offset:17408
    ds_read_b64_tr_b16 v[70:71], v21 offset:17920
    v_mov_b32 v63, s57
    s_waitcnt vmcnt(14)
    s_mov_b64 exec, 1
    buffer_store_dword v63, off, s[32:35], s51 offset:0 sc1
    s_mov_b64 exec, -1
    s_waitcnt lgkmcnt(8)
    v_mfma_f32_32x32x16_bf16 v[80:95], v[76:79], v[236:239], v[80:95]
    ds_read_b64_tr_b16 v[72:73], v22 offset:17408
    ds_read_b64_tr_b16 v[74:75], v22 offset:17920
    s_waitcnt lgkmcnt(4)
    v_mfma_f32_16x16x32_bf16 v[48:51], v[44:47], v[64:67], v[48:51]
    v_mfma_f32_32x32x16_bf16 v[80:95], v[64:67], v[240:243], v[80:95]
    ds_read_b64_tr_b16 v[76:77], v23 offset:17408
    ds_read_b64_tr_b16 v[78:79], v23 offset:17920
    s_waitcnt lgkmcnt(4)
    v_mfma_f32_32x32x16_bf16 v[80:95], v[68:71], v[244:247], v[80:95]
    s_nop 2
    ds_write_b32 v14, v48 offset:1024
    s_waitcnt lgkmcnt(0)
    s_barrier
    s_cmp_lt_u32 s3, 3
    s_cbranch_scc0 L_p6_19
    s_add_u32 m0, s56, 16384
    s_mov_b32 s6, 163840
    buffer_load_dwordx4 v32, s[20:23], s6 offen lds
    buffer_load_dwordx4 v33, s[20:23], s6 offen offset:1024 lds
    s_add_u32 m0, s56, 81920
    s_mov_b32 s6, 180224
    buffer_load_dwordx4 v32, s[20:23], s6 offen lds
    buffer_load_dwordx4 v33, s[20:23], s6 offen offset:1024 lds
L_p6_19:
    s_setprio 3
    v_mfma_f32_32x32x16_bf16 v[80:95], v[72:75], v[248:251], v[80:95]
    ds_read_b128 v[44:47], v15 offset:1024
    v_xor_b32 v40, v57, v40
    v_xor_b32 v41, v57, v41
    v_xor_b32 v42, v57, v42
    v_xor_b32 v43, v57, v43
    v_xor_b32 v52, v57, v52
    v_xor_b32 v53, v57, v53
    v_xor_b32 v54, v57, v54
    v_xor_b32 v55, v57, v55
    v_mfma_f32_32x32x16_bf16 v[80:95], v[76:79], v[252:255], v[80:95]
    s_waitcnt lgkmcnt(0)
    v_add_f32 v44, v44, v45
    v_add_f32 v46, v46, v47
    v_add_f32 v44, v44, v46
    v_cndmask_b32 v44, 0, v44, s[40:41]
    s_nop 4
    v_mfma_f32_32x32x2_f32 v[80:95], v44, v10, v[80:95]
    s_nop 15
    s_nop 1
    v_cvt_pk_bf16_f32 v80, v80, v81
    v_cvt_pk_bf16_f32 v81, v82, v83
    v_cvt_pk_bf16_f32 v82, v84, v85
    v_cvt_pk_bf16_f32 v83, v86, v87
    v_cvt_pk_bf16_f32 v84, v88, v89
    v_cvt_pk_bf16_f32 v85, v90, v91
    v_cvt_pk_bf16_f32 v86, v92, v93
    v_cvt_pk_bf16_f32 v87, v94, v95
    v_mfma_f32_32x32x16_bf16 v[216:231], v[40:43], v[80:83], 0
    s_nop 0
    v_mfma_f32_32x32x16_bf16 v[232:247], v[52:55], v[84:87], 0
    buffer_load_dwordx4 v[64:67], v59, s[32:35], 0 offen offset:1024 sc1
    s_nop 8
    v_max3_f32 v20, v216, v217, v218
    v_max3_f32 v21, v219, v220, v221
    s_movk_i32 s7, 0
    buffer_load_dwordx4 v[96:99], v58, s[32:35], s7 offen offset:0 sc1
    v_max3_f32 v20, v20, v222, v223
    v_max3_f32 v21, v21, v224, v225
    s_movk_i32 s7, 0
    buffer_load_dwordx4 v[100:103], v58, s[32:35], s7 offen offset:256 sc1
    v_max3_f32 v20, v20, v226, v227
    v_max3_f32 v21, v21, v228, v229
    s_movk_i32 s7, 4608
    buffer_load_dwordx4 v[104:107], v58, s[32:35], s7 offen offset:0 sc1
    v_max3_f32 v20, v20, v230, v231
    v_max_f32 v20, v20, v21
    s_movk_i32 s7, 4608
    buffer_load_dwordx4 v[108:111], v58, s[32:35], s7 offen offset:256 sc1
    v_mul_f32 v20, v20, v12
    v_pk_fma_f32 v[216:217], v[216:217], v[12:13], v[20:21] op_sel_hi:[1,0,0] neg_lo:[0,0,1] neg_hi:[0,0,1]
    v_pk_fma_f32 v[218:219], v[218:219], v[12:13], v[20:21] op_sel_hi:[1,0,0] neg_lo:[0,0,1] neg_hi:[0,0,1]
    s_movk_i32 s7, 9216
    buffer_load_dwordx4 v[112:115], v58, s[32:35], s7 offen offset:0 sc1
    v_pk_fma_f32 v[220:221], v[220:221], v[12:13], v[20:21] op_sel_hi:[1,0,0] neg_lo:[0,0,1] neg_hi:[0,0,1]
    v_pk_fma_f32 v[222:223], v[222:223], v[12:13], v[20:21] op_sel_hi:[1,0,0] neg_lo:[0,0,1] neg_hi:[0,0,1]
    s_movk_i32 s7, 9216
    buffer_load_dwordx4 v[116:119], v58, s[32:35], s7 offen offset:256 sc1
    v_pk_fma_f32 v[224:225], v[224:225], v[12:13], v[20:21] op_sel_hi:[1,0,0] neg_lo:[0,0,1] neg_hi:[0,0,1]
    v_pk_fma_f32 v[226:227], v[226:227], v[12:13], v[20:21] op_sel_hi:[1,0,0] neg_lo:[0,0,1] neg_hi:[0,0,1]
    s_movk_i32 s7, 13824
    buffer_load_dwordx4 v[120:123], v58, s[32:35], s7 offen offset:0 sc1
    v_pk_fma_f32 v[228:229], v[228:229], v[12:13], v[20:21] op_sel_hi:[1,0,0] neg_lo:[0,0,1] neg_hi:[0,0,1]
    v_pk_fma_f32 v[230:231], v[230:231], v[12:13], v[20:21] op_sel_hi:[1,0,0] neg_lo:[0,0,1] neg_hi:[0,0,1]
    s_movk_i32 s7, 13824
    buffer_load_dwordx4 v[124:127], v58, s[32:35], s7 offen offset:256 sc1
    v_exp_f32 v216, v216
    v_exp_f32 v217, v217
    v_exp_f32 v218, v218
    v_exp_f32 v219, v219
    s_mov_b64 exec, s[42:43]
    buffer_load_dword v39, v36, s[32:35], s52 offen offset:0 sc1
    s_mov_b64 exec, -1
    v_exp_f32 v220, v220
    v_exp_f32 v221, v221
    v_exp_f32 v222, v222
    v_exp_f32 v223, v223
    v_exp_f32 v224, v224
    v_exp_f32 v225, v225
    v_exp_f32 v226, v226
    v_exp_f32 v227, v227
    v_exp_f32 v228, v228
    s_add_u32 m0, s56, 0
    s_xor_b32 s6, s54, 32768
    buffer_load_dwordx4 v34, s[24:27], s6 offen lds
    buffer_load_dwordx4 v35, s[24:27], s6 offen offset:1024 lds
    v_exp_f32 v229, v229
    v_exp_f32 v230, v230
    v_exp_f32 v231, v231
    v_pk_add_f32 v[20:21], v[216:217], v[218:219]
    v_pk_add_f32 v[22:23], v[220:221], v[222:223]
    v_pk_add_f32 v[20:21], v[20:21], v[224:225]
    v_pk_add_f32 v[22:23], v[22:23], v[226:227]
    v_pk_add_f32 v[20:21], v[20:21], v[228:229]
    v_pk_add_f32 v[22:23], v[22:23], v[230:231]
    v_pk_add_f32 v[20:21], v[20:21], v[22:23]
    v_add_f32 v20, v20, v21
    v_rcp_f32 v20, v20
    s_nop 0
    v_pk_mul_f32 v[216:217], v[216:217], v[20:21] op_sel_hi:[1,0]
    v_pk_mul_f32 v[218:219], v[218:219], v[20:21] op_sel_hi:[1,0]
    v_pk_mul_f32 v[220:221], v[220:221], v[20:21] op_sel_hi:[1,0]
    s_add_u32 m0, s56, 65536
    s_xor_b32 s6, s54, 49152
    buffer_load_dwordx4 v34, s[24:27], s6 offen lds
    buffer_load_dwordx4 v35, s[24:27], s6 offen offset:1024 lds
    v_pk_mul_f32 v[222:223], v[222:223], v[20:21] op_sel_hi:[1,0]
    v_pk_mul_f32 v[224:225], v[224:225], v[20:21] op_sel_hi:[1,0]
    v_pk_mul_f32 v[226:227], v[226:227], v[20:21] op_sel_hi:[1,0]
    v_pk_mul_f32 v[228:229], v[228:229], v[20:21] op_sel_hi:[1,0]
    v_pk_mul_f32 v[230:231], v[230:231], v[20:21] op_sel_hi:[1,0]
    v_cvt_pk_bf16_f32 v216, v216, v217
    v_cvt_pk_bf16_f32 v217, v218, v219
    v_cvt_pk_bf16_f32 v218, v220, v221
    v_cvt_pk_bf16_f32 v219, v222, v223
    v_cvt_pk_bf16_f32 v220, v224, v225
    v_cvt_pk_bf16_f32 v221, v226, v227
    v_cvt_pk_bf16_f32 v222, v228, v229
    v_cvt_pk_bf16_f32 v223, v230, v231
    v_max3_f32 v20, v232, v233, v234
    v_max3_f32 v21, v235, v236, v237
    v_max3_f32 v20, v20, v238, v239
    v_max3_f32 v21, v21, v240, v241
    v_max3_f32 v20, v20, v242, v243
    v_max3_f32 v21, v21, v244, v245
    v_max3_f32 v20, v20, v246, v247
    v_max_f32 v20, v20, v21
    v_mul_f32 v20, v20, v12
    v_pk_fma_f32 v[232:233], v[232:233], v[12:13], v[20:21] op_sel_hi:[1,0,0] neg_lo:[0,0,1] neg_hi:[0,0,1]
    v_pk_fma_f32 v[234:235], v[234:235], v[12:13], v[20:21] op_sel_hi:[1,0,0] neg_lo:[0,0,1] neg_hi:[0,0,1]
    v_pk_fma_f32 v[236:237], v[236:237], v[12:13], v[20:21] op_sel_hi:[1,0,0] neg_lo:[0,0,1] neg_hi:[0,0,1]
    v_pk_fma_f32 v[238:239], v[238:239], v[12:13], v[20:21] op_sel_hi:[1,0,0] neg_lo:[0,0,1] neg_hi:[0,0,1]
    v_pk_fma_f32 v[240:241], v[240:241], v[12:13], v[20:21] op_sel_hi:[1,0,0] neg_lo:[0,0,1] neg_hi:[0,0,1]
    v_pk_fma_f32 v[242:243], v[242:243], v[12:13], v[20:21] op_sel_hi:[1,0,0] neg_lo:[0,0,1] neg_hi:[0,0,1]
    v_pk_fma_f32 v[244:245], v[244:245], v[12:13], v[20:21] op_sel_hi:[1,0,0] neg_lo:[0,0,1] neg_hi:[0,0,1]
    v_pk_fma_f32 v[246:247], v[246:247], v[12:13], v[20:21] op_sel_hi:[1,0,0] neg_lo:[0,0,1] neg_hi:[0,0,1]
    v_exp_f32 v232, v232
    v_exp_f32 v233, v233
    v_exp_f32 v234, v234
    v_exp_f32 v235, v235
    v_exp_f32 v236, v236
    v_exp_f32 v237, v237
    v_exp_f32 v238, v238
    v_exp_f32 v239, v239
    v_exp_f32 v240, v240
    v_exp_f32 v241, v241
    v_exp_f32 v242, v242
    v_exp_f32 v243, v243
    v_exp_f32 v244, v244
    v_exp_f32 v245, v245
    v_exp_f32 v246, v246
    v_exp_f32 v247, v247
    v_pk_add_f32 v[20:21], v[232:233], v[234:235]
    v_pk_add_f32 v[22:23], v[236:237], v[238:239]
    v_pk_add_f32 v[20:21], v[20:21], v[240:241]
    v_pk_add_f32 v[22:23], v[22:23], v[242:243]
    v_pk_add_f32 v[20:21], v[20:21], v[244:245]
    v_pk_add_f32 v[22:23], v[22:23], v[246:247]
    v_pk_add_f32 v[20:21], v[20:21], v[22:23]
    v_add_f32 v20, v20, v21
    v_rcp_f32 v20, v20
    s_waitcnt vmcnt(5)
L_t_20_c:
    v_max3_u32 v88, v96, v100, v104
    v_max3_u32 v88, v88, v108, v112
    v_max3_u32 v88, v88, v116, v120
    v_max3_u32 v88, v88, v124, v64
    v_cmp_eq_u32 vcc, -1, v88
    s_cbranch_vccnz L_t_20_r
L_t_20_k:
    v_mfma_f32_16x16x32_bf16 v[92:95], v[24:27], v[64:67], 0
    v_mfma_f32_16x16x32_bf16 v[88:91], v[24:27], v[96:99], 0
    v_mfma_f32_16x16x32_bf16 v[88:91], v[28:31], v[100:103], v[88:91]
    v_mfma_f32_16x16x32_bf16 v[88:91], v[24:27], v[104:107], v[88:91]
    v_mfma_f32_16x16x32_bf16 v[88:91], v[28:31], v[108:111], v[88:91]
    v_mfma_f32_16x16x32_bf16 v[88:91], v[24:27], v[112:115], v[88:91]
    v_mfma_f32_16x16x32_bf16 v[88:91], v[28:31], v[116:119], v[88:91]
    v_mfma_f32_16x16x32_bf16 v[88:91], v[24:27], v[120:123], v[88:91]
    v_mfma_f32_16x16x32_bf16 v[88:91], v[28:31], v[124:127], v[88:91]
    v_add_f32_dpp v92, v92, v92 row_ror:2 row_mask:0xf bank_mask:0xf
    v_add_f32_dpp v93, v93, v93 row_ror:2 row_mask:0xf bank_mask:0xf
    v_add_f32_dpp v94, v94, v94 row_ror:2 row_mask:0xf bank_mask:0xf
    v_add_f32_dpp v95, v95, v95 row_ror:2 row_mask:0xf bank_mask:0xf
    v_add_f32_dpp v92, v92, v92 row_ror:4 row_mask:0xf bank_mask:0xf
    v_add_f32_dpp v93, v93, v93 row_ror:4 row_mask:0xf bank_mask:0xf
    v_add_f32_dpp v94, v94, v94 row_ror:4 row_mask:0xf bank_mask:0xf
    v_add_f32_dpp v95, v95, v95 row_ror:4 row_mask:0xf bank_mask:0xf
    v_cvt_pk_bf16_f32 v92, v92, v93
    v_cvt_pk_bf16_f32 v93, v94, v95
    s_mov_b64 exec, 0x30003
    ds_write_b64 v61, v[92:93] offset:256
    s_mov_b64 exec, -1
    v_cvt_pk_bf16_f32 v88, v88, v89
    v_cvt_pk_bf16_f32 v89, v90, v91
    ds_write_b64 v60, v[88:89]
    v_pk_mul_f32 v[232:233], v[232:233], v[20:21] op_sel_hi:[1,0]
    v_pk_mul_f32 v[234:235], v[234:235], v[20:21] op_sel_hi:[1,0]
    v_pk_mul_f32 v[236:237], v[236:237], v[20:21] op_sel_hi:[1,0]
    v_pk_mul_f32 v[238:239], v[238:239], v[20:21] op_sel_hi:[1,0]
    v_pk_mul_f32 v[240:241], v[240:241], v[20:21] op_sel_hi:[1,0]
    v_pk_mul_f32 v[242:243], v[242:243], v[20:21] op_sel_hi:[1,0]
    v_pk_mul_f32 v[244:245], v[244:245], v[20:21] op_sel_hi:[1,0]
    v_pk_mul_f32 v[246:247], v[246:247], v[20:21] op_sel_hi:[1,0]
    v_cvt_pk_bf16_f32 v224, v232, v233
    v_cvt_pk_bf16_f32 v225, v234, v235
    v_cvt_pk_bf16_f32 v226, v236, v237
    v_cvt_pk_bf16_f32 v227, v238, v239
    v_cvt_pk_bf16_f32 v228, v240, v241
    v_cvt_pk_bf16_f32 v229, v242, v243
    v_cvt_pk_bf16_f32 v230, v244, v245
    v_cvt_pk_bf16_f32 v231, v246, v247
    s_waitcnt vmcnt(4)
L_fl_21_c:
    v_cmp_ne_u32 vcc, s57, v39
    s_and_b64 vcc, vcc, s[42:43]
    s_cbranch_vccnz L_fl_21_r
L_fl_21_k:
    s_xor_b32 s7, s70, 0
    buffer_load_dwordx4 v[192:195], v37, s[32:35], s7 offen offset:0 sc1
    buffer_load_dwordx4 v[196:199], v37, s[32:35], s7 offen offset:1024 sc1
    s_xor_b32 s7, s70, 2048
    buffer_load_dwordx4 v[200:203], v37, s[32:35], s7 offen offset:0 sc1
    buffer_load_dwordx4 v[204:207], v37, s[32:35], s7 offen offset:1024 sc1
    s_xor_b32 s7, s70, 4096
    buffer_load_dwordx4 v[208:211], v37, s[32:35], s7 offen offset:0 sc1
    buffer_load_dwordx4 v[212:215], v37, s[32:35], s7 offen offset:1024 sc1
    s_xor_b32 s7, s70, 6144
    buffer_load_dwordx4 v[248:251], v37, s[32:35], s7 offen offset:0 sc1
    buffer_load_dwordx4 v[252:255], v37, s[32:35], s7 offen offset:1024 sc1
    s_waitcnt lgkmcnt(0)
    s_barrier
    ds_read_b128 v[64:67], v62 offset:0
    ds_read_b128 v[68:71], v62 offset:272
    ds_read_b128 v[72:75], v62 offset:1088
    ds_read_b128 v[76:79], v62 offset:1360
    v_bfe_u32 v22, v0, 2, 2
    v_lshrrev_b32 v23, 5, v0
    v_lshl_add_u32 v23, v23, 2, v22
    v_lshlrev_b32 v9, 4, v23
    v_and_b32 v8, 16, v0
    v_lshlrev_b32 v8, 2, v8
    v_lshl_add_u32 v8, v23, 10, v8
    v_and_b32 v23, 3, v0
    s_waitcnt lgkmcnt(2)
    v_mfma_f32_32x32x16_bf16 v[80:95], v[64:67], v[216:219], 0
    v_mfma_f32_32x32x16_bf16 v[80:95], v[68:71], v[220:223], v[80:95]
    s_waitcnt lgkmcnt(0)
    v_mfma_f32_32x32x16_bf16 v[112:127], v[72:75], v[224:227], 0
    v_mfma_f32_32x32x16_bf16 v[112:127], v[76:79], v[228:231], v[112:127]
    v_lshl_add_u32 v8, v23, 4, v8
    v_add_u32 v20, s56, v7
    s_lshl_b32 s59, s5, 16
    s_lshl_b32 s60, s4, 7
    s_add_u32 s59, s59, s60
    v_lshl_add_u32 v21, v22, 4, s59
    v_and_b32 v22, 1, v0
    v_mul_u32_u24 v22, 16448, v22
    v_bfe_u32 v23, v0, 1, 1
    v_mul_u32_u24 v23, 32896, v23
    v_add3_u32 v21, v21, v22, v23
    v_lshrrev_b32 v22, 4, v0
    v_lshl_add_u32 v21, v22, 11, v21
    v_add_u32 v23, 0x10000, v20
    v_add_f32 v88, 0x358637bd, v88
    v_add_f32 v120, 0x358637bd, v120
    v_rcp_f32 v88, v88
    v_rcp_f32 v120, v120
    v_mul_f32 v88, v88, v11
    v_mul_f32 v120, v120, v11
    v_pk_mul_f32 v[80:81], v[80:81], v[88:89] op_sel_hi:[1,0]
    v_pk_mul_f32 v[82:83], v[82:83], v[88:89] op_sel_hi:[1,0]
    v_pk_mul_f32 v[84:85], v[84:85], v[88:89] op_sel_hi:[1,0]
    v_pk_mul_f32 v[86:87], v[86:87], v[88:89] op_sel_hi:[1,0]
    v_cvt_pk_bf16_f32 v92, v80, v81
    v_cvt_pk_bf16_f32 v93, v82, v83
    v_cvt_pk_bf16_f32 v94, v84, v85
    v_cvt_pk_bf16_f32 v95, v86, v87
    buffer_store_dwordx4 v[92:95], v7, s[32:35], s66 offen offset:0 sc1
    v_pk_mul_f32 v[112:113], v[112:113], v[120:121] op_sel_hi:[1,0]
    v_pk_mul_f32 v[114:115], v[114:115], v[120:121] op_sel_hi:[1,0]
    v_pk_mul_f32 v[116:117], v[116:117], v[120:121] op_sel_hi:[1,0]
    v_pk_mul_f32 v[118:119], v[118:119], v[120:121] op_sel_hi:[1,0]
    v_cvt_pk_bf16_f32 v124, v112, v113
    v_cvt_pk_bf16_f32 v125, v114, v115
    v_cvt_pk_bf16_f32 v126, v116, v117
    v_cvt_pk_bf16_f32 v127, v118, v119
    buffer_store_dwordx4 v[124:127], v7, s[32:35], s66 offen offset:2048 sc1
    s_setprio 0
    s_lshr_b32 s59, s56, 1
    s_sub_u32 s60, 155648, s59
    s_add_u32 s59, s59, 155648
    v_add_u32 v38, s59, v7
    v_add_u32 v56, s60, v1
    v_add_u32 v57, s60, v2
    ds_write_b128 v38, v[132:135]
    ds_read_b64_tr_b16 v[128:129], v56
    ds_read_b64_tr_b16 v[132:133], v57
    buffer_load_dwordx2 v[14:15], v9, s[32:35], s73 offen offset:8 sc1
    buffer_load_dwordx4 v[16:19], v8, s[8:11], s69 offen
    ds_write_b128 v38, v[136:139]
    ds_read_b64_tr_b16 v[130:131], v56
    ds_read_b64_tr_b16 v[134:135], v57
    ds_write_b128 v38, v[140:143]
    ds_read_b64_tr_b16 v[136:137], v56
    ds_read_b64_tr_b16 v[140:141], v57
    ds_write_b128 v38, v[144:147]
    ds_read_b64_tr_b16 v[138:139], v56
    ds_read_b64_tr_b16 v[142:143], v57
    ds_write_b128 v38, v[148:151]
    ds_read_b64_tr_b16 v[144:145], v56
    ds_read_b64_tr_b16 v[148:149], v57
    ds_write_b128 v38, v[152:155]
    ds_read_b64_tr_b16 v[146:147], v56
    ds_read_b64_tr_b16 v[150:151], v57
    ds_write_b128 v38, v[156:159]
    ds_read_b64_tr_b16 v[152:153], v56
    ds_read_b64_tr_b16 v[156:157], v57
    ds_write_b128 v38, v[160:163]
    ds_read_b64_tr_b16 v[154:155], v56
    ds_read_b64_tr_b16 v[158:159], v57
    ds_write_b128 v38, v[164:167]
    ds_read_b64_tr_b16 v[160:161], v56
    ds_read_b64_tr_b16 v[164:165], v57
    ds_write_b128 v38, v[168:171]
    ds_read_b64_tr_b16 v[162:163], v56
    ds_read_b64_tr_b16 v[166:167], v57
    ds_write_b128 v38, v[172:175]
    ds_read_b64_tr_b16 v[168:169], v56
    ds_read_b64_tr_b16 v[172:173], v57
    ds_write_b128 v38, v[176:179]
    ds_read_b64_tr_b16 v[170:171], v56
    ds_read_b64_tr_b16 v[174:175], v57
    ds_write_b128 v38, v[180:183]
    ds_read_b64_tr_b16 v[176:177], v56
    ds_read_b64_tr_b16 v[180:181], v57
    ds_write_b128 v38, v[184:187]
    ds_read_b64_tr_b16 v[178:179], v56
    ds_read_b64_tr_b16 v[182:183], v57
    s_waitcnt vmcnt(10) lgkmcnt(15)
    v_mfma_f32_32x32x16_bf16 v[64:79], v[128:131], v[192:195], 0
    s_xor_b32 s7, s70, 8192
    buffer_load_dwordx4 v[216:219], v37, s[32:35], s7 offen offset:0 sc1
    buffer_load_dwordx4 v[220:223], v37, s[32:35], s7 offen offset:1024 sc1
    v_mfma_f32_32x32x16_bf16 v[80:95], v[132:135], v[192:195], 0
    s_xor_b32 s7, s70, 10240
    buffer_load_dwordx4 v[224:227], v37, s[32:35], s7 offen offset:0 sc1
    buffer_load_dwordx4 v[228:231], v37, s[32:35], s7 offen offset:1024 sc1
    v_mfma_f32_32x32x16_bf16 v[96:111], v[128:131], v[196:199], 0
    s_xor_b32 s7, s70, 12288
    buffer_load_dwordx4 v[232:235], v37, s[32:35], s7 offen offset:0 sc1
    buffer_load_dwordx4 v[236:239], v37, s[32:35], s7 offen offset:1024 sc1
    v_mfma_f32_32x32x16_bf16 v[112:127], v[132:135], v[196:199], 0
    s_xor_b32 s7, s70, 14336
    buffer_load_dwordx4 v[240:243], v37, s[32:35], s7 offen offset:0 sc1
    buffer_load_dwordx4 v[244:247], v37, s[32:35], s7 offen offset:1024 sc1
    s_waitcnt vmcnt(16)
    v_mfma_f32_32x32x16_bf16 v[64:79], v[136:139], v[200:203], v[64:79]
    ds_read_b64_tr_b16 v[128:129], v5 offset:0
    v_mfma_f32_32x32x16_bf16 v[80:95], v[140:143], v[200:203], v[80:95]
    ds_read_b64_tr_b16 v[130:131], v5 offset:1024
    v_mfma_f32_32x32x16_bf16 v[96:111], v[136:139], v[204:207], v[96:111]
    ds_read_b64_tr_b16 v[132:133], v6 offset:0
    v_mfma_f32_32x32x16_bf16 v[112:127], v[140:143], v[204:207], v[112:127]
    ds_read_b64_tr_b16 v[134:135], v6 offset:1024
    s_waitcnt vmcnt(14)
    v_mfma_f32_32x32x16_bf16 v[64:79], v[144:147], v[208:211], v[64:79]
    s_cmp_lt_u32 s3, 3
    s_cbranch_scc0 L_p6_22
    s_movk_i32 s7, 20480
    buffer_load_dwordx4 v[48:51], v37, s[32:35], s7 offen offset:0 sc1
    buffer_load_dwordx4 v[52:55], v37, s[32:35], s7 offen offset:1024 sc1
    s_movk_i32 s7, 22528
    buffer_load_dwordx4 v[56:59], v37, s[32:35], s7 offen offset:0 sc1
    buffer_load_dwordx4 v[60:63], v37, s[32:35], s7 offen offset:1024 sc1
L_p6_22:
    s_movk_i32 s7, 16384
    buffer_load_dwordx4 v[184:187], v37, s[32:35], s7 offen offset:0 sc1
    buffer_load_dwordx4 v[188:191], v37, s[32:35], s7 offen offset:1024 sc1
    v_mfma_f32_32x32x16_bf16 v[80:95], v[148:151], v[208:211], v[80:95]
    s_movk_i32 s7, 18432
    buffer_load_dwordx4 v[40:43], v37, s[32:35], s7 offen offset:0 sc1
    buffer_load_dwordx4 v[44:47], v37, s[32:35], s7 offen offset:1024 sc1
    v_mfma_f32_32x32x16_bf16 v[96:111], v[144:147], v[212:215], v[96:111]
    ds_read_b64_tr_b16 v[136:137], v1 offset:32768
    v_mfma_f32_32x32x16_bf16 v[112:127], v[148:151], v[212:215], v[112:127]
    ds_read_b64_tr_b16 v[138:139], v1 offset:33792
    ds_read_b64_tr_b16 v[140:141], v2 offset:32768
    ds_read_b64_tr_b16 v[142:143], v2 offset:33792
    s_waitcnt vmcnt(16)
    v_mfma_f32_32x32x16_bf16 v[64:79], v[152:155], v[248:251], v[64:79]
    ds_read_b64_tr_b16 v[144:145], v1 offset:49152
    v_mfma_f32_32x32x16_bf16 v[80:95], v[156:159], v[248:251], v[80:95]
    ds_read_b64_tr_b16 v[146:147], v1 offset:50176
    v_mfma_f32_32x32x16_bf16 v[96:111], v[152:155], v[252:255], v[96:111]
    ds_read_b64_tr_b16 v[148:149], v2 offset:49152
    v_mfma_f32_32x32x16_bf16 v[112:127], v[156:159], v[252:255], v[112:127]
    ds_read_b64_tr_b16 v[150:151], v2 offset:50176
    s_waitcnt vmcnt(10) lgkmcnt(15)
    v_mfma_f32_32x32x16_bf16 v[64:79], v[160:163], v[216:219], v[64:79]
    v_mfma_f32_32x32x16_bf16 v[80:95], v[164:167], v[216:219], v[80:95]
    v_mfma_f32_32x32x16_bf16 v[96:111], v[160:163], v[220:223], v[96:111]
    v_mfma_f32_32x32x16_bf16 v[112:127], v[164:167], v[220:223], v[112:127]
    s_waitcnt vmcnt(8)
    v_mfma_f32_32x32x16_bf16 v[64:79], v[168:171], v[224:227], v[64:79]
    s_xor_b32 s7, s53, 0
    s_add_u32 s7, s72, s7
    buffer_load_dwordx4 v[192:195], v37, s[32:35], s7 offen offset:0 sc1
    s_xor_b32 s7, s53, 2048
    s_add_u32 s7, s72, s7
    buffer_load_dwordx4 v[200:203], v37, s[32:35], s7 offen offset:0 sc1
    s_xor_b32 s7, s53, 4096
    s_add_u32 s7, s72, s7
    buffer_load_dwordx4 v[208:211], v37, s[32:35], s7 offen offset:0 sc1
    v_mfma_f32_32x32x16_bf16 v[80:95], v[172:175], v[224:227], v[80:95]
    s_xor_b32 s7, s53, 6144
    s_add_u32 s7, s72, s7
    buffer_load_dwordx4 v[248:251], v37, s[32:35], s7 offen offset:0 sc1
    s_xor_b32 s7, s53, 0
    s_add_u32 s7, s72, s7
    buffer_load_dwordx4 v[196:199], v37, s[32:35], s7 offen offset:1024 sc1
    v_mfma_f32_32x32x16_bf16 v[96:111], v[168:171], v[228:231], v[96:111]
    s_xor_b32 s7, s53, 2048
    s_add_u32 s7, s72, s7
    buffer_load_dwordx4 v[204:207], v37, s[32:35], s7 offen offset:1024 sc1
    s_xor_b32 s7, s53, 4096
    s_add_u32 s7, s72, s7
    buffer_load_dwordx4 v[212:215], v37, s[32:35], s7 offen offset:1024 sc1
    s_xor_b32 s7, s53, 6144
    s_add_u32 s7, s72, s7
    buffer_load_dwordx4 v[252:255], v37, s[32:35], s7 offen offset:1024 sc1
    v_mfma_f32_32x32x16_bf16 v[112:127], v[172:175], v[228:231], v[112:127]
    s_cmp_lt_u32 s3, 3
    s_cbranch_scc0 L_p6_23
    ds_read_b64_tr_b16 v[152:153], v1 offset:16384
    ds_read_b64_tr_b16 v[154:155], v1 offset:17408
    ds_read_b64_tr_b16 v[156:157], v2 offset:16384
    ds_read_b64_tr_b16 v[158:159], v2 offset:17408
    ds_read_b64_tr_b16 v[160:161], v3 offset:16384
    ds_read_b64_tr_b16 v[162:163], v3 offset:17408
    ds_read_b64_tr_b16 v[164:165], v4 offset:16384
    ds_read_b64_tr_b16 v[166:167], v4 offset:17408
L_p6_23:
    s_waitcnt vmcnt(14) lgkmcnt(12)
    v_mfma_f32_32x32x16_bf16 v[64:79], v[176:179], v[232:235], v[64:79]
    ds_read_b64_tr_b16 v[168:169], v3 offset:32768
    v_mfma_f32_32x32x16_bf16 v[80:95], v[180:183], v[232:235], v[80:95]
    ds_read_b64_tr_b16 v[170:171], v3 offset:33792
    v_mfma_f32_32x32x16_bf16 v[96:111], v[176:179], v[236:239], v[96:111]
    ds_read_b64_tr_b16 v[172:173], v4 offset:32768
    v_mfma_f32_32x32x16_bf16 v[112:127], v[180:183], v[236:239], v[112:127]
    ds_read_b64_tr_b16 v[174:175], v4 offset:33792
    s_waitcnt vmcnt(12) lgkmcnt(12)
    v_mfma_f32_32x32x16_bf16 v[64:79], v[128:131], v[240:243], v[64:79]
    ds_read_b64_tr_b16 v[176:177], v3 offset:49152
    v_mfma_f32_32x32x16_bf16 v[80:95], v[132:135], v[240:243], v[80:95]
    ds_read_b64_tr_b16 v[178:179], v3 offset:50176
    v_mfma_f32_32x32x16_bf16 v[96:111], v[128:131], v[244:247], v[96:111]
    ds_read_b64_tr_b16 v[180:181], v4 offset:49152
    v_mfma_f32_32x32x16_bf16 v[112:127], v[132:135], v[244:247], v[112:127]
    ds_read_b64_tr_b16 v[182:183], v4 offset:50176
    s_waitcnt vmcnt(8)
L_s_24_c:
    v_max3_u32 v22, v184, v188, v40
    v_max_u32 v22, v22, v44
    v_cmp_eq_u32 vcc, -1, v22
    s_cbranch_vccnz L_s_24_r
L_s_24_k:
    s_waitcnt lgkmcnt(12)
    v_mfma_f32_32x32x16_bf16 v[64:79], v[136:139], v[184:187], v[64:79]
    ds_read_b64_tr_b16 v[128:129], v1 offset:0
    v_mfma_f32_32x32x16_bf16 v[80:95], v[140:143], v[184:187], v[80:95]
    ds_read_b64_tr_b16 v[130:131], v1 offset:1024
    v_mfma_f32_32x32x16_bf16 v[96:111], v[136:139], v[188:191], v[96:111]
    ds_read_b64_tr_b16 v[132:133], v2 offset:0
    v_mfma_f32_32x32x16_bf16 v[112:127], v[140:143], v[188:191], v[112:127]
    ds_read_b64_tr_b16 v[134:135], v2 offset:1024
    s_waitcnt lgkmcnt(12)
    v_mfma_f32_32x32x16_bf16 v[64:79], v[144:147], v[40:43], v[64:79]
    ds_read_b64_tr_b16 v[136:137], v3 offset:0
    v_mfma_f32_32x32x16_bf16 v[80:95], v[148:151], v[40:43], v[80:95]
    ds_read_b64_tr_b16 v[138:139], v3 offset:1024
    v_mfma_f32_32x32x16_bf16 v[96:111], v[144:147], v[44:47], v[96:111]
    ds_read_b64_tr_b16 v[140:141], v4 offset:0
    v_mfma_f32_32x32x16_bf16 v[112:127], v[148:151], v[44:47], v[112:127]
    ds_read_b64_tr_b16 v[142:143], v4 offset:1024
    s_waitcnt lgkmcnt(12)
    s_cmp_lt_u32 s3, 3
    s_cbranch_scc0 L_p6_25
L_s_26_c:
    v_max3_u32 v22, v48, v52, v56
    v_max_u32 v22, v22, v60
    v_cmp_eq_u32 vcc, -1, v22
    s_cbranch_vccnz L_s_26_r
L_s_26_k:
    v_mfma_f32_32x32x16_bf16 v[64:79], v[152:155], v[48:51], v[64:79]
    v_mfma_f32_32x32x16_bf16 v[80:95], v[156:159], v[48:51], v[80:95]
    v_mfma_f32_32x32x16_bf16 v[96:111], v[152:155], v[52:55], v[96:111]
    v_mfma_f32_32x32x16_bf16 v[112:127], v[156:159], v[52:55], v[112:127]
    v_mfma_f32_32x32x16_bf16 v[64:79], v[160:163], v[56:59], v[64:79]
    v_mfma_f32_32x32x16_bf16 v[80:95], v[164:167], v[56:59], v[80:95]
    v_mfma_f32_32x32x16_bf16 v[96:111], v[160:163], v[60:63], v[96:111]
    v_mfma_f32_32x32x16_bf16 v[112:127], v[164:167], v[60:63], v[112:127]
L_p6_25:
    s_waitcnt vmcnt(4) lgkmcnt(0)
L_s_27_c:
    v_max3_u32 v22, v192, v200, v208
    v_max_u32 v22, v22, v248
    v_cmp_eq_u32 vcc, -1, v22
    s_cbranch_vccnz L_s_27_r
L_s_27_k:
L_rs_28_c:
    v_cmp_ne_u32 vcc, s57, v15
    s_cbranch_vccnz L_rs_28_r
L_rs_28_k:
    v_mfma_f32_32x32x16_bf16 v[64:79], v[168:171], v[192:195], v[64:79]
    v_lshlrev_b32 v216, 16, v16
    v_mfma_f32_32x32x16_bf16 v[80:95], v[172:175], v[192:195], v[80:95]
    v_and_b32 v217, s44, v16
    v_mfma_f32_32x32x16_bf16 v[64:79], v[176:179], v[200:203], v[64:79]
    v_lshlrev_b32 v218, 16, v17
    v_mfma_f32_32x32x16_bf16 v[80:95], v[180:183], v[200:203], v[80:95]
    v_and_b32 v219, s44, v17
    v_mfma_f32_32x32x16_bf16 v[64:79], v[128:131], v[208:211], v[64:79]
    v_lshlrev_b32 v220, 16, v18
    v_mfma_f32_32x32x16_bf16 v[80:95], v[132:135], v[208:211], v[80:95]
    v_and_b32 v221, s44, v18
    v_mfma_f32_32x32x16_bf16 v[64:79], v[136:139], v[248:251], v[64:79]
    v_lshlrev_b32 v222, 16, v19
    v_mfma_f32_32x32x16_bf16 v[80:95], v[140:143], v[248:251], v[80:95]
    v_and_b32 v223, s44, v19
    s_waitcnt vmcnt(0)
L_s_29_c:
    v_max3_u32 v22, v196, v204, v212
    v_max_u32 v22, v22, v252
    v_cmp_eq_u32 vcc, -1, v22
    s_cbranch_vccnz L_s_29_r
L_s_29_k:
    v_mfma_f32_32x32x16_bf16 v[96:111], v[168:171], v[196:199], v[96:111]
    v_mfma_f32_32x32x16_bf16 v[112:127], v[172:175], v[196:199], v[112:127]
    s_nop 1
    v_cvt_pk_bf16_f32 v64, v64, v65
    v_cvt_pk_bf16_f32 v65, v66, v67
    v_cvt_pk_bf16_f32 v66, v80, v81
    v_cvt_pk_bf16_f32 v67, v82, v83
    v_mfma_f32_32x32x16_bf16 v[96:111], v[176:179], v[204:207], v[96:111]
    ds_write_b128 v20, v[64:67] offset:0
    v_cvt_pk_bf16_f32 v68, v68, v69
    v_mfma_f32_32x32x16_bf16 v[112:127], v[180:183], v[204:207], v[112:127]
    v_cvt_pk_bf16_f32 v69, v70, v71
    v_cvt_pk_bf16_f32 v70, v84, v85
    v_cvt_pk_bf16_f32 v71, v86, v87
    ds_write_b128 v20, v[68:71] offset:16448
    v_mfma_f32_32x32x16_bf16 v[96:111], v[128:131], v[212:215], v[96:111]
    v_cvt_pk_bf16_f32 v72, v72, v73
    v_cvt_pk_bf16_f32 v73, v74, v75
    v_mfma_f32_32x32x16_bf16 v[112:127], v[132:135], v[212:215], v[112:127]
    v_cvt_pk_bf16_f32 v74, v88, v89
    v_cvt_pk_bf16_f32 v75, v90, v91
    ds_write_b128 v20, v[72:75] offset:32896
    v_mfma_f32_32x32x16_bf16 v[96:111], v[136:139], v[252:255], v[96:111]
    v_cvt_pk_bf16_f32 v76, v76, v77
    v_cvt_pk_bf16_f32 v77, v78, v79
    v_cvt_pk_bf16_f32 v78, v92, v93
    v_mfma_f32_32x32x16_bf16 v[112:127], v[140:143], v[252:255], v[112:127]
    v_cvt_pk_bf16_f32 v79, v94, v95
    ds_write_b128 v20, v[76:79] offset:49344
    s_nop 5
    v_cvt_pk_bf16_f32 v96, v96, v97
    v_cvt_pk_bf16_f32 v97, v98, v99
    s_nop 1
    v_cvt_pk_bf16_f32 v98, v112, v113
    v_cvt_pk_bf16_f32 v99, v114, v115
    ds_write_b128 v23, v[96:99] offset:0
    v_cvt_pk_bf16_f32 v100, v100, v101
    v_cvt_pk_bf16_f32 v101, v102, v103
    v_cvt_pk_bf16_f32 v102, v116, v117
    v_cvt_pk_bf16_f32 v103, v118, v119
    ds_write_b128 v23, v[100:103] offset:16448
    v_cvt_pk_bf16_f32 v104, v104, v105
    v_cvt_pk_bf16_f32 v105, v106, v107
    v_cvt_pk_bf16_f32 v106, v120, v121
    v_cvt_pk_bf16_f32 v107, v122, v123
    ds_write_b128 v23, v[104:107] offset:32896
    v_cvt_pk_bf16_f32 v108, v108, v109
    v_cvt_pk_bf16_f32 v109, v110, v111
    v_cvt_pk_bf16_f32 v110, v124, v125
    v_cvt_pk_bf16_f32 v111, v126, v127
    ds_write_b128 v23, v[108:111] offset:49344
    s_waitcnt lgkmcnt(0)
    s_barrier
    ds_read_b128 v[224:227], v21 offset:0
    ds_read_b128 v[228:231], v21 offset:8192
    ds_read_b128 v[232:235], v21 offset:64
    ds_read_b128 v[236:239], v21 offset:8256
    ds_read_b128 v[240:243], v21 offset:512
    ds_read_b128 v[244:247], v21 offset:8704
    ds_read_b128 v[248:251], v21 offset:576
    ds_read_b128 v[252:255], v21 offset:8768
    s_waitcnt lgkmcnt(7)
    v_mfma_f32_16x16x32_bf16 v[128:131], v[24:27], v[224:227], 0
    s_waitcnt lgkmcnt(6)
    v_mfma_f32_16x16x32_bf16 v[128:131], v[24:27], v[228:231], v[128:131]
    s_waitcnt lgkmcnt(3)
    v_mfma_f32_16x16x32_bf16 v[132:135], v[24:27], v[240:243], 0
    s_waitcnt lgkmcnt(2)
    v_mfma_f32_16x16x32_bf16 v[132:135], v[24:27], v[244:247], v[132:135]
    v_mfma_f32_16x16x32_bf16 v[128:131], v[28:31], v[232:235], v[128:131]
    v_mfma_f32_16x16x32_bf16 v[128:131], v[28:31], v[236:239], v[128:131]
    s_waitcnt lgkmcnt(1)
    v_mfma_f32_16x16x32_bf16 v[132:135], v[28:31], v[248:251], v[132:135]
    s_waitcnt lgkmcnt(0)
    v_mfma_f32_16x16x32_bf16 v[132:135], v[28:31], v[252:255], v[132:135]
    s_nop 3
    v_pk_fma_f32 v[128:129], v[128:129], v[14:15], v[216:217] op_sel_hi:[1,0,1]
    v_pk_fma_f32 v[130:131], v[130:131], v[14:15], v[218:219] op_sel_hi:[1,0,1]
    s_nop 1
    v_pk_fma_f32 v[132:133], v[132:133], v[14:15], v[220:221] op_sel_hi:[1,0,1]
    v_pk_fma_f32 v[134:135], v[134:135], v[14:15], v[222:223] op_sel_hi:[1,0,1]
    v_cvt_pk_bf16_f32 v136, v128, v129
    v_cvt_pk_bf16_f32 v137, v130, v131
    v_cvt_pk_bf16_f32 v138, v132, v133
    v_cvt_pk_bf16_f32 v139, v134, v135
    buffer_store_dwordx4 v[136:139], v8, s[28:31], s69 offen sc1 nt
    s_branch L_fin
L_rec1_2_r:
    s_cmp_eq_u32 s58, 0
    s_cbranch_scc1 L_rec1_2_k
    s_sub_u32 s58, s58, 1
    buffer_load_dwordx4 v[10:13], v6, s[32:35], 0 offen sc1
    s_waitcnt vmcnt(0)
    s_branch L_rec1_2_c
L_fl_5_r:
    s_cmp_eq_u32 s58, 0
    s_cbranch_scc1 L_fl_5_k
    s_sub_u32 s58, s58, 1
    s_mov_b64 exec, s[42:43]
    buffer_load_dword v39, v36, s[32:35], s52 offen offset:0 sc1
    s_mov_b64 exec, -1
    s_waitcnt vmcnt(0)
    s_branch L_fl_5_c
L_s_9_r:
    s_cmp_eq_u32 s58, 0
    s_cbranch_scc1 L_s_9_k
    s_sub_u32 s58, s58, 1
    s_movk_i32 s7, 16384
    buffer_load_dwordx4 v[184:187], v37, s[32:35], s7 offen offset:0 sc1
    buffer_load_dwordx4 v[188:191], v37, s[32:35], s7 offen offset:1024 sc1
    s_movk_i32 s7, 18432
    buffer_load_dwordx4 v[40:43], v37, s[32:35], s7 offen offset:0 sc1
    buffer_load_dwordx4 v[44:47], v37, s[32:35], s7 offen offset:1024 sc1
    s_waitcnt vmcnt(0)
    s_branch L_s_9_c
L_s_11_r:
    s_cmp_eq_u32 s58, 0
    s_cbranch_scc1 L_s_11_k
    s_sub_u32 s58, s58, 1
    s_movk_i32 s7, 20480
    buffer_load_dwordx4 v[48:51], v37, s[32:35], s7 offen offset:0 sc1
    buffer_load_dwordx4 v[52:55], v37, s[32:35], s7 offen offset:1024 sc1
    s_movk_i32 s7, 22528
    buffer_load_dwordx4 v[56:59], v37, s[32:35], s7 offen offset:0 sc1
    buffer_load_dwordx4 v[60:63], v37, s[32:35], s7 offen offset:1024 sc1
    s_waitcnt vmcnt(0)
    s_branch L_s_11_c
L_s_12_r:
    s_cmp_eq_u32 s58, 0
    s_cbranch_scc1 L_s_12_k
    s_sub_u32 s58, s58, 1
    s_xor_b32 s7, s53, 0
    s_add_u32 s7, s72, s7
    buffer_load_dwordx4 v[192:195], v37, s[32:35], s7 offen offset:0 sc1
    s_xor_b32 s7, s53, 2048
    s_add_u32 s7, s72, s7
    buffer_load_dwordx4 v[200:203], v37, s[32:35], s7 offen offset:0 sc1
    s_xor_b32 s7, s53, 4096
    s_add_u32 s7, s72, s7
    buffer_load_dwordx4 v[208:211], v37, s[32:35], s7 offen offset:0 sc1
    s_xor_b32 s7, s53, 6144
    s_add_u32 s7, s72, s7
    buffer_load_dwordx4 v[248:251], v37, s[32:35], s7 offen offset:0 sc1
    s_waitcnt vmcnt(0)
    s_branch L_s_12_c
L_rs_13_r:
    s_cmp_eq_u32 s58, 0
    s_cbranch_scc1 L_rs_13_k
    s_sub_u32 s58, s58, 1
    buffer_load_dwordx2 v[14:15], v9, s[32:35], s73 offen offset:8 sc1
    s_waitcnt vmcnt(0)
    s_branch L_rs_13_c
L_s_14_r:
    s_cmp_eq_u32 s58, 0
    s_cbranch_scc1 L_s_14_k
    s_sub_u32 s58, s58, 1
    s_xor_b32 s7, s53, 0
    s_add_u32 s7, s72, s7
    buffer_load_dwordx4 v[196:199], v37, s[32:35], s7 offen offset:1024 sc1
    s_xor_b32 s7, s53, 2048
    s_add_u32 s7, s72, s7
    buffer_load_dwordx4 v[204:207], v37, s[32:35], s7 offen offset:1024 sc1
    s_xor_b32 s7, s53, 4096
    s_add_u32 s7, s72, s7
    buffer_load_dwordx4 v[212:215], v37, s[32:35], s7 offen offset:1024 sc1
    s_xor_b32 s7, s53, 6144
    s_add_u32 s7, s72, s7
    buffer_load_dwordx4 v[252:255], v37, s[32:35], s7 offen offset:1024 sc1
    s_waitcnt vmcnt(0)
    s_branch L_s_14_c
L_epc_16_r:
    s_cmp_eq_u32 s58, 0
    s_cbranch_scc1 L_epc_16_k
    s_sub_u32 s58, s58, 1
    v_lshlrev_b32 v38, 7, v0
    s_mov_b32 s59, 4096
    buffer_load_dword v10, v38, s[32:35], s59 offen offset:12 sc1
    s_mov_b32 s59, 12288
    buffer_load_dword v11, v38, s[32:35], s59 offen offset:12 sc1
    s_mov_b32 s59, 20480
    buffer_load_dword v12, v38, s[32:35], s59 offen offset:12 sc1
    s_mov_b32 s59, 28672
    buffer_load_dword v13, v38, s[32:35], s59 offen offset:12 sc1
    s_waitcnt vmcnt(0)
    s_branch L_epc_16_c
L_rec1_17_r:
    s_cmp_eq_u32 s58, 0
    s_cbranch_scc1 L_rec1_17_k
    s_sub_u32 s58, s58, 1
    buffer_load_dwordx4 v[10:13], v6, s[32:35], 0 offen sc1
    s_waitcnt vmcnt(0)
    s_branch L_rec1_17_c
L_fl_18_r:
    s_cmp_eq_u32 s58, 0
    s_cbranch_scc1 L_fl_18_k
    s_sub_u32 s58, s58, 1
    s_mov_b64 exec, s[44:45]
    buffer_load_dword v39, v36, s[32:35], 0 offen offset:12 sc1
    s_mov_b64 exec, -1
    s_waitcnt vmcnt(0)
    s_branch L_fl_18_c
L_t_20_r:
    s_cmp_eq_u32 s58, 0
    s_cbranch_scc1 L_t_20_k
    s_sub_u32 s58, s58, 1
    buffer_load_dwordx4 v[64:67], v59, s[32:35], 0 offen offset:1024 sc1
    s_movk_i32 s7, 0
    buffer_load_dwordx4 v[96:99], v58, s[32:35], s7 offen offset:0 sc1
    s_movk_i32 s7, 0
    buffer_load_dwordx4 v[100:103], v58, s[32:35], s7 offen offset:256 sc1
    s_movk_i32 s7, 4608
    buffer_load_dwordx4 v[104:107], v58, s[32:35], s7 offen offset:0 sc1
    s_movk_i32 s7, 4608
    buffer_load_dwordx4 v[108:111], v58, s[32:35], s7 offen offset:256 sc1
    s_movk_i32 s7, 9216
    buffer_load_dwordx4 v[112:115], v58, s[32:35], s7 offen offset:0 sc1
    s_movk_i32 s7, 9216
    buffer_load_dwordx4 v[116:119], v58, s[32:35], s7 offen offset:256 sc1
    s_movk_i32 s7, 13824
    buffer_load_dwordx4 v[120:123], v58, s[32:35], s7 offen offset:0 sc1
    s_movk_i32 s7, 13824
    buffer_load_dwordx4 v[124:127], v58, s[32:35], s7 offen offset:256 sc1
    s_waitcnt vmcnt(0)
    s_branch L_t_20_c
L_fl_21_r:
    s_cmp_eq_u32 s58, 0
    s_cbranch_scc1 L_fl_21_k
    s_sub_u32 s58, s58, 1
    s_mov_b64 exec, s[42:43]
    buffer_load_dword v39, v36, s[32:35], s52 offen offset:0 sc1
    s_mov_b64 exec, -1
    s_waitcnt vmcnt(0)
    s_branch L_fl_21_c
L_s_24_r:
    s_cmp_eq_u32 s58, 0
    s_cbranch_scc1 L_s_24_k
    s_sub_u32 s58, s58, 1
    s_movk_i32 s7, 16384
    buffer_load_dwordx4 v[184:187], v37, s[32:35], s7 offen offset:0 sc1
    buffer_load_dwordx4 v[188:191], v37, s[32:35], s7 offen offset:1024 sc1
    s_movk_i32 s7, 18432
    buffer_load_dwordx4 v[40:43], v37, s[32:35], s7 offen offset:0 sc1
    buffer_load_dwordx4 v[44:47], v37, s[32:35], s7 offen offset:1024 sc1
    s_waitcnt vmcnt(0)
    s_branch L_s_24_c
L_s_26_r:
    s_cmp_eq_u32 s58, 0
    s_cbranch_scc1 L_s_26_k
    s_sub_u32 s58, s58, 1
    s_movk_i32 s7, 20480
    buffer_load_dwordx4 v[48:51], v37, s[32:35], s7 offen offset:0 sc1
    buffer_load_dwordx4 v[52:55], v37, s[32:35], s7 offen offset:1024 sc1
    s_movk_i32 s7, 22528
    buffer_load_dwordx4 v[56:59], v37, s[32:35], s7 offen offset:0 sc1
    buffer_load_dwordx4 v[60:63], v37, s[32:35], s7 offen offset:1024 sc1
    s_waitcnt vmcnt(0)
    s_branch L_s_26_c
L_s_27_r:
    s_cmp_eq_u32 s58, 0
    s_cbranch_scc1 L_s_27_k
    s_sub_u32 s58, s58, 1
    s_xor_b32 s7, s53, 0
    s_add_u32 s7, s72, s7
    buffer_load_dwordx4 v[192:195], v37, s[32:35], s7 offen offset:0 sc1
    s_xor_b32 s7, s53, 2048
    s_add_u32 s7, s72, s7
    buffer_load_dwordx4 v[200:203], v37, s[32:35], s7 offen offset:0 sc1
    s_xor_b32 s7, s53, 4096
    s_add_u32 s7, s72, s7
    buffer_load_dwordx4 v[208:211], v37, s[32:35], s7 offen offset:0 sc1
    s_xor_b32 s7, s53, 6144
    s_add_u32 s7, s72, s7
    buffer_load_dwordx4 v[248:251], v37, s[32:35], s7 offen offset:0 sc1
    s_waitcnt vmcnt(0)
    s_branch L_s_27_c
L_rs_28_r:
    s_cmp_eq_u32 s58, 0
    s_cbranch_scc1 L_rs_28_k
    s_sub_u32 s58, s58, 1
    buffer_load_dwordx2 v[14:15], v9, s[32:35], s73 offen offset:8 sc1
    s_waitcnt vmcnt(0)
    s_branch L_rs_28_c
L_s_29_r:
    s_cmp_eq_u32 s58, 0
    s_cbranch_scc1 L_s_29_k
    s_sub_u32 s58, s58, 1
    s_xor_b32 s7, s53, 0
    s_add_u32 s7, s72, s7
    buffer_load_dwordx4 v[196:199], v37, s[32:35], s7 offen offset:1024 sc1
    s_xor_b32 s7, s53, 2048
    s_add_u32 s7, s72, s7
    buffer_load_dwordx4 v[204:207], v37, s[32:35], s7 offen offset:1024 sc1
    s_xor_b32 s7, s53, 4096
    s_add_u32 s7, s72, s7
    buffer_load_dwordx4 v[212:215], v37, s[32:35], s7 offen offset:1024 sc1
    s_xor_b32 s7, s53, 6144
    s_add_u32 s7, s72, s7
    buffer_load_dwordx4 v[252:255], v37, s[32:35], s7 offen offset:1024 sc1
    s_waitcnt vmcnt(0)
    s_branch L_s_29_c
L_fin:
L_end:

s_endpgm
.section .rodata,"a"
.p2align 6
.amdhsa_kernel parallel_sum__linear_kernel_hedgehog__dense_activation_mish__prompt_kernel
  .amdhsa_next_free_vgpr 256
  .amdhsa_next_free_sgpr 102
  .amdhsa_accum_offset 256
  .amdhsa_group_segment_fixed_size 0
  .amdhsa_kernarg_size 88
  .amdhsa_user_sgpr_count 2
  .amdhsa_user_sgpr_kernarg_segment_ptr 1
  .amdhsa_system_sgpr_workgroup_id_x 1
.end_amdhsa_kernel
```
